```python
import torch

def _softmax(x, axis=-1):
    return torch.softmax(x, dim=axis)
def _gelu(x):
    return torch.nn.functional.gelu(x, approximate="tanh")
def _silu(x):
    return torch.nn.functional.silu(x)
def _sigmoid(x):
    return torch.sigmoid(x)
def _layernorm(x, axis=-1, eps=1e-5):
    m = x.mean(dim=axis, keepdim=True)
    v = x.var(dim=axis, keepdim=True, unbiased=False)
    return (x - m) / torch.sqrt(v + eps)
def _scatter_add(tgt, idx, src, axis=0):
    return tgt.clone().index_add_(axis, idx, src)
def _segment_sum(src, seg, n):
    out = torch.zeros((n,) + src.shape[1:], dtype=src.dtype)
    return out.index_add_(0, seg, src)
def _pad(x, pw):
    flat = tuple(v for pair in reversed(pw) for v in pair)
    return torch.nn.functional.pad(x, flat)

kernel_name = 'sequential_preLN__mha_block_cached__glu_gated_swiglu__decode'

def setup_inputs():

    _w = (lambda a: (lambda t: t.to(torch.bfloat16) if t.is_floating_point() else t)(torch.as_tensor(a)))
    def _A_setup():
        B, Sq, D = 1, 1, 576
        H, Sk, Dh = 32, 8192, 128
        return {
            "x": _w((lambda *s: torch.randn(*s, dtype=torch.bfloat16) * 0.05)(B, Sq, D)),
            "k_cache": _w((lambda *s: torch.randn(*s, dtype=torch.bfloat16) * 1.6)(B, H, Sk, Dh)),
            "v_cache": _w((lambda *s: torch.randn(*s, dtype=torch.bfloat16) * 0.8)(B, H, Sk, Dh)),
            "wq": _w((lambda *s: torch.randn(*s, dtype=torch.bfloat16) * 1.6)(D, H * Dh) * (D ** -0.5)),
            "wo": _w((lambda *s: torch.randn(*s, dtype=torch.bfloat16) * 0.8)(H * Dh, D) * ((H * Dh) ** -0.5)),
        }
    _A_in = _A_setup()

    def _B_setup():
        B, S, D, F = 1, 1, 576, 4608
        return {
            "x": _w((lambda *s: torch.randn(*s, dtype=torch.bfloat16) * 0.05)(B, S, D)),
            "w1": _w((lambda *s: torch.randn(*s, dtype=torch.bfloat16) * 0.4)(D, F) * (2.0 / D) ** 0.5),
            "w3": _w((lambda *s: torch.randn(*s, dtype=torch.bfloat16) * 0.4)(D, F) * (2.0 / D) ** 0.5),
            "w2": _w((lambda *s: torch.randn(*s, dtype=torch.bfloat16) * 0.4)(F, D) * (2.0 / F) ** 0.5),
        }
    _B_in = _B_setup()

    return {
        "A_x": _A_in["x"],
        "A_k_cache": _A_in["k_cache"],
        "A_v_cache": _A_in["v_cache"],
        "A_wq": _A_in["wq"],
        "A_wo": _A_in["wo"],
        "B_x": _B_in["x"],
        "B_w1": _B_in["w1"],
        "B_w3": _B_in["w3"],
        "B_w2": _B_in["w2"],
    }

def reference(A_x, A_k_cache, A_v_cache, A_wq, A_wo, B_x, B_w1, B_w3, B_w2):
    def _A_ref(x, k_cache, v_cache, wq, wo):
        B, Sq, D = x.shape
        H, Dh = 32, 128
        q = (lambda x, *d: x.permute(*d))((x @ wq).reshape(B, Sq, H, Dh), 0, 2, 1, 3)
        scores = torch.einsum("bhqd,bhkd->bhqk", q, k_cache) * (Dh ** -0.5)
        p = _softmax(scores, axis=-1)
        o = torch.einsum("bhqk,bhkd->bhqd", p, v_cache)
        return (lambda x, *d: x.permute(*d))(o, 0, 2, 1, 3).reshape(B, Sq, H * Dh) @ wo

    def _B_ref(x, w1, w3, w2):
        gate = torch.einsum("bsd,df->bsf", x, w1)
        up = torch.einsum("bsd,df->bsf", x, w3)
        h = _silu(gate) * up
        out = torch.einsum("bsf,fd->bsd", h, w2)
        return out

    x = A_x
    h = x + _A_ref(_layernorm(x, axis=-1), A_k_cache, A_v_cache, A_wq, A_wo)
    h2 = h + _B_ref(_layernorm(h, axis=-1), B_w1, B_w3, B_w2)
    return h2
```

```asm
; @launch grid=(256,1,1) block=(512,1,1) lds=62464
.amdgcn_target "amdgcn-amd-amdhsa--gfx950"
.text
.globl sequential_preLN__mha_block_cached__glu_gated_swiglu__decode_kernel
.p2align 8
.type sequential_preLN__mha_block_cached__glu_gated_swiglu__decode_kernel,@function
sequential_preLN__mha_block_cached__glu_gated_swiglu__decode_kernel:
s_load_dwordx2 s[28:29], s[0:1], 8
s_load_dwordx2 s[40:41], s[0:1], 0
s_load_dwordx2 s[36:37], s[0:1], 24
s_cmp_ge_u32 s2, 256
s_cbranch_scc1 L_done
s_and_b32 s60, s2, 7
s_lshr_b32 s61, s2, 3
s_and_b32 s68, s61, 3
s_lshl2_add_u32 s62, s60, s68
s_lshr_b32 s63, s2, 5
s_lshl3_add_u32 s79, s62, s63
s_lshl_b32 s64, s79, 18
v_lshlrev_b32 v4, 4, v0
s_mov_b32 s30, 0x4000000
s_mov_b32 s31, 0x20000
s_mov_b32 s65, s64
s_waitcnt lgkmcnt(0)
buffer_load_dwordx4 v[64:67], v4, s[28:31], s64 offen nt
s_addk_i32 s64, 8192
buffer_load_dwordx4 v[68:71], v4, s[28:31], s64 offen nt
s_addk_i32 s64, 8192
buffer_load_dwordx4 v[72:75], v4, s[28:31], s64 offen nt
s_addk_i32 s64, 8192
buffer_load_dwordx4 v[76:79], v4, s[28:31], s64 offen nt
s_addk_i32 s64, 8192
s_load_dwordx2 s[32:33], s[0:1], 16
s_load_dwordx2 s[44:45], s[0:1], 88
s_load_dwordx2 s[56:57], s[0:1], 80
s_load_dwordx2 s[12:13], s[0:1], 32
s_load_dwordx8 s[16:23], s[0:1], 48
v_and_b32 v1, 63, v0
s_mov_b32 s42, 1152
s_mov_b32 s43, 0x20000
v_lshlrev_b32 v11, 3, v1
v_and_b32 v3, 15, v0
v_lshrrev_b32 v7, 4, v0
buffer_load_dwordx2 v[56:57], v11, s[40:43], 0 offen offset:0
buffer_load_dwordx2 v[58:59], v11, s[40:43], 0 offen offset:512
buffer_load_dwordx2 v[60:61], v11, s[40:43], 0 offen offset:1024
s_mul_i32 s69, s63, 9
s_lshr_b32 s69, s69, 2
v_add_u32 v8, s69, v3
v_subrev_u32 v9, 18, v8
v_min_u32 v9, v8, v9
v_lshl_add_u32 v9, v9, 5, v7
v_lshlrev_b32 v9, 1, v9
buffer_load_ushort v62, v9, s[40:43], 0 offen
v_add_u32 v8, 16, v8
v_subrev_u32 v9, 18, v8
v_min_u32 v9, v8, v9
v_lshl_add_u32 v9, v9, 5, v7
v_lshlrev_b32 v9, 1, v9
buffer_load_ushort v63, v9, s[40:43], 0 offen
v_lshlrev_b32 v5, 13, v7
s_lshl_b32 s66, s69, 18
s_lshl_b32 s68, s62, 8
v_lshl_add_u32 v5, v3, 4, v5
v_add_u32 v5, s68, v5
s_mov_b32 s38, 4718592
s_mov_b32 s39, 0x20000
v_mov_b32 v22, 0x7ffffff0
v_lshrrev_b32 v6, 6, v0
v_lshrrev_b32 v2, 4, v1
v_readfirstlane_b32 s3, v6
v_and_b32 v6, 1, v1
v_lshlrev_b32 v6, 4, v6
v_mov_b32 v7, 0xffff
v_lshlrev_b32 v6, v6, v7
v_bfe_u32 v7, v1, 1, 2
v_cmp_eq_u32 s[4:5], 0, v7
v_cmp_eq_u32 s[6:7], 1, v7
s_nop 0
v_cndmask_b32 v12, 0, v6, s[4:5]
v_cmp_eq_u32 s[4:5], 2, v7
v_cndmask_b32 v13, 0, v6, s[6:7]
v_cmp_eq_u32 s[6:7], 3, v7
v_cndmask_b32 v14, 0, v6, s[4:5]
s_nop 0
v_cndmask_b32 v15, 0, v6, s[6:7]
v_mov_b32 v6, 0
v_mov_b32 v7, 0
v_mov_b32 v8, 0x3f803f80
buffer_load_dwordx4 v[80:83], v5, s[36:39], s66 offen
s_add_u32 s66, s66, 0x40000
s_cmp_eq_u32 s66, 0x480000
s_cselect_b32 s66, 0, s66
s_waitcnt vmcnt(9)
buffer_load_dwordx4 v[84:87], v4, s[28:31], s64 offen nt
s_addk_i32 s64, 8192
s_waitcnt vmcnt(9)
buffer_load_dwordx4 v[88:91], v4, s[28:31], s64 offen nt
s_addk_i32 s64, 8192
s_waitcnt vmcnt(9)
buffer_load_dwordx4 v[92:95], v5, s[36:39], s66 offen
s_add_u32 s66, s66, 0x40000
s_cmp_eq_u32 s66, 0x480000
s_cselect_b32 s66, 0, s66
s_waitcnt vmcnt(9)
buffer_load_dwordx4 v[96:99], v4, s[28:31], s64 offen nt
s_addk_i32 s64, 8192
s_waitcnt vmcnt(4)
buffer_load_dwordx4 v[100:103], v4, s[28:31], s64 offen nt
s_addk_i32 s64, 8192
v_dot2c_f32_bf16 v6, v56, v8
v_dot2c_f32_bf16 v7, v56, v56
v_dot2c_f32_bf16 v6, v57, v8
v_dot2c_f32_bf16 v7, v57, v57
v_dot2c_f32_bf16 v6, v58, v8
v_dot2c_f32_bf16 v7, v58, v58
v_dot2c_f32_bf16 v6, v59, v8
v_dot2c_f32_bf16 v7, v59, v59
v_dot2c_f32_bf16 v6, v60, v8
v_dot2c_f32_bf16 v7, v60, v60
v_dot2c_f32_bf16 v6, v61, v8
v_dot2c_f32_bf16 v7, v61, v61
s_nop 1
v_add_f32_dpp v6, v6, v6 row_ror:8 row_mask:0xf bank_mask:0xf
v_add_f32_dpp v7, v7, v7 row_ror:8 row_mask:0xf bank_mask:0xf
s_nop 0
v_add_f32_dpp v6, v6, v6 row_ror:4 row_mask:0xf bank_mask:0xf
v_add_f32_dpp v7, v7, v7 row_ror:4 row_mask:0xf bank_mask:0xf
s_nop 0
v_add_f32_dpp v6, v6, v6 row_ror:2 row_mask:0xf bank_mask:0xf
v_add_f32_dpp v7, v7, v7 row_ror:2 row_mask:0xf bank_mask:0xf
s_nop 0
v_add_f32_dpp v6, v6, v6 row_ror:1 row_mask:0xf bank_mask:0xf
v_add_f32_dpp v7, v7, v7 row_ror:1 row_mask:0xf bank_mask:0xf
s_nop 0
v_add_f32_dpp v6, v6, v6 row_bcast:15 row_mask:0xa bank_mask:0xf
v_add_f32_dpp v7, v7, v7 row_bcast:15 row_mask:0xa bank_mask:0xf
s_nop 0
v_add_f32_dpp v6, v6, v6 row_bcast:31 row_mask:0xc bank_mask:0xf
v_add_f32_dpp v7, v7, v7 row_bcast:31 row_mask:0xc bank_mask:0xf
v_readlane_b32 s68, v6, 63
v_readlane_b32 s69, v7, 63
v_mov_b32 v7, 0x3ae38e39
v_mul_f32 v6, s68, v7
v_mul_f32 v7, s69, v7
v_fma_f32 v7, -v6, v6, v7
v_max_f32 v7, 0, v7
v_cvt_pk_bf16_f32 v7, v7, v7
v_cvt_pk_bf16_f32 v6, v6, v6
v_and_b32 v7, 0xffff0000, v7
v_add_f32 v7, 0x3727c5ac, v7
v_cvt_pk_bf16_f32 v7, v7, v7
v_and_b32 v7, 0xffff0000, v7
v_sqrt_f32 v7, v7
v_and_b32 v6, 0xffff0000, v6
v_cvt_pk_bf16_f32 v7, v7, v7
v_and_b32 v7, 0xffff0000, v7
v_rcp_f32 v7, v7
v_lshlrev_b32 v20, 16, v62
v_lshlrev_b32 v21, 16, v63
v_sub_f32 v20, v20, v6
v_sub_f32 v21, v21, v6
v_cvt_pk_bf16_f32 v20, v20, v20
v_and_b32 v20, 0xffff0000, v20
v_cvt_pk_bf16_f32 v21, v21, v21
v_and_b32 v21, 0xffff0000, v21
v_mul_f32 v20, v20, v7
v_mul_f32 v21, v21, v7
v_cvt_pk_bf16_f32 v20, v20, v20
v_cvt_pk_bf16_f32 v21, v21, v21
s_nop 0
v_and_b32_dpp v24, v20, v12 row_newbcast:0 row_mask:0xf bank_mask:0xf
v_and_b32_dpp v25, v20, v13 row_newbcast:0 row_mask:0xf bank_mask:0xf
v_and_b32_dpp v26, v20, v14 row_newbcast:0 row_mask:0xf bank_mask:0xf
v_and_b32_dpp v27, v20, v15 row_newbcast:0 row_mask:0xf bank_mask:0xf
s_nop 1
v_mfma_f32_16x16x32_bf16 v[28:31], v[24:27], v[80:83], 0
s_waitcnt vmcnt(4)
buffer_load_dwordx4 v[104:107], v5, s[36:39], s66 offen
s_add_u32 s66, s66, 0x40000
s_cmp_eq_u32 s66, 0x480000
s_cselect_b32 s66, 0, s66
s_waitcnt vmcnt(4)
buffer_load_dwordx4 v[108:111], v4, s[28:31], s64 offen nt
s_addk_i32 s64, 8192
s_waitcnt vmcnt(4)
buffer_load_dwordx4 v[112:115], v4, s[28:31], s64 offen nt
s_addk_i32 s64, 8192
v_and_b32_dpp v24, v20, v12 row_newbcast:1 row_mask:0xf bank_mask:0xf
v_and_b32_dpp v25, v20, v13 row_newbcast:1 row_mask:0xf bank_mask:0xf
v_and_b32_dpp v26, v20, v14 row_newbcast:1 row_mask:0xf bank_mask:0xf
v_and_b32_dpp v27, v20, v15 row_newbcast:1 row_mask:0xf bank_mask:0xf
s_nop 1
v_mfma_f32_16x16x32_bf16 v[28:31], v[24:27], v[92:95], v[28:31]
s_waitcnt vmcnt(4)
buffer_load_dwordx4 v[116:119], v5, s[36:39], s66 offen
s_add_u32 s66, s66, 0x40000
s_cmp_eq_u32 s66, 0x480000
s_cselect_b32 s66, 0, s66
s_waitcnt vmcnt(4)
buffer_load_dwordx4 v[120:123], v4, s[28:31], s64 offen nt
s_addk_i32 s64, 8192
s_waitcnt vmcnt(4)
buffer_load_dwordx4 v[124:127], v4, s[28:31], s64 offen nt
s_addk_i32 s64, 8192
v_and_b32_dpp v24, v20, v12 row_newbcast:2 row_mask:0xf bank_mask:0xf
v_and_b32_dpp v25, v20, v13 row_newbcast:2 row_mask:0xf bank_mask:0xf
v_and_b32_dpp v26, v20, v14 row_newbcast:2 row_mask:0xf bank_mask:0xf
v_and_b32_dpp v27, v20, v15 row_newbcast:2 row_mask:0xf bank_mask:0xf
s_nop 1
v_mfma_f32_16x16x32_bf16 v[28:31], v[24:27], v[104:107], v[28:31]
s_waitcnt vmcnt(4)
buffer_load_dwordx4 v[128:131], v5, s[36:39], s66 offen
s_add_u32 s66, s66, 0x40000
s_cmp_eq_u32 s66, 0x480000
s_cselect_b32 s66, 0, s66
s_waitcnt vmcnt(4)
buffer_load_dwordx4 v[132:135], v4, s[28:31], s64 offen nt
s_addk_i32 s64, 8192
s_waitcnt lgkmcnt(0)
s_mov_b32 s34, 0x4000000
s_mov_b32 s35, 0x20000
s_mov_b32 s46, 0x140000
s_mov_b32 s47, 0x20000
s_mov_b32 s58, 0x100
s_mov_b32 s59, 0x20000
v_cmp_gt_u32 vcc, 168, v0
s_mul_i32 s68, s2, 2688
v_mov_b32 v40, -1
v_mov_b32 v41, -1
v_mov_b32 v42, -1
v_mov_b32 v43, -1
v_lshlrev_b32 v6, 4, v0
v_cndmask_b32 v6, v22, v6, vcc
buffer_store_dwordx4 v[40:43], v6, s[44:47], s68 offen sc1
s_lshl3_add_u32 s68, s60, s3
s_lshl_b32 s68, s68, 7
s_add_u32 s101, s68, 688128
s_lshr_b32 s69, s2, 2
s_cmp_eq_u32 s69, 62
s_cselect_b32 s69, 2, 0
v_cmp_gt_u32 vcc, s69, v1
v_lshlrev_b32 v6, 13, v1
s_nop 0
v_cndmask_b32 v6, v22, v6, vcc
buffer_store_dword v40, v6, s[44:47], s101 offen sc1
s_mul_i32 s68, s60, 9
s_add_u32 s69, s68, s61
s_add_u32 s68, s68, s69
s_sub_u32 s68, s68, 9
s_cmp_lt_u32 s61, 9
s_cselect_b32 s67, s69, s68
s_lshl4_add_u32 s69, s79, 262144
v_mov_b32 v23, s69
v_cmp_eq_u32 vcc, 224, v0
s_lshl_b32 s68, s79, 9
s_and_b32 s69, s68, 0xffffe000
s_add_u32 s68, s68, s69
v_cndmask_b32 v23, v22, v23, vcc
v_and_b32 v6, 7, v1
v_bfe_u32 v7, v1, 3, 1
v_lshl_add_u32 v6, v6, 1, v7
v_bfe_u32 v7, v1, 4, 1
v_lshl_add_u32 v6, v6, 1, v7
v_lshlrev_b32 v35, 2, v6
s_lshl_b32 s69, s3, 7
s_add_u32 s68, s68, s69
v_add_u32 v6, s68, v35
v_and_b32 v7, 0x120, v0
v_cmp_eq_u32 vcc, 0, v7
s_mov_b32 s72, 0xaaaaaaaa
s_mov_b32 s73, 0xaaaaaaaa
v_cndmask_b32 v36, v22, v6, vcc
s_mov_b32 s74, 0xcccccccc
s_mov_b32 s75, 0xcccccccc
v_and_b32 v6, 1, v2
v_lshlrev_b32 v6, 4, v6
v_lshl_add_u32 v6, v3, 5, v6
s_lshl_b32 s68, s3, 9
v_add_u32 v38, s68, v6
s_lshl_b32 s69, s3, 2
v_mov_b32 v39, s69
s_mov_b32 s71, 2000000
s_waitcnt vmcnt(6)
buffer_load_dwordx4 v[136:139], v4, s[28:31], s64 offen nt
s_addk_i32 s64, 8192
v_and_b32_dpp v24, v20, v12 row_newbcast:3 row_mask:0xf bank_mask:0xf
v_and_b32_dpp v25, v20, v13 row_newbcast:3 row_mask:0xf bank_mask:0xf
v_and_b32_dpp v26, v20, v14 row_newbcast:3 row_mask:0xf bank_mask:0xf
v_and_b32_dpp v27, v20, v15 row_newbcast:3 row_mask:0xf bank_mask:0xf
s_nop 1
v_mfma_f32_16x16x32_bf16 v[28:31], v[24:27], v[116:119], v[28:31]
s_waitcnt vmcnt(6)
buffer_load_dwordx4 v[140:143], v5, s[36:39], s66 offen
s_add_u32 s66, s66, 0x40000
s_cmp_eq_u32 s66, 0x480000
s_cselect_b32 s66, 0, s66
s_waitcnt vmcnt(6)
buffer_load_dwordx4 v[144:147], v4, s[28:31], s64 offen nt
s_addk_i32 s64, 8192
s_waitcnt vmcnt(6)
buffer_load_dwordx4 v[148:151], v4, s[28:31], s64 offen nt
s_addk_i32 s64, 8192
v_and_b32_dpp v24, v20, v12 row_newbcast:4 row_mask:0xf bank_mask:0xf
v_and_b32_dpp v25, v20, v13 row_newbcast:4 row_mask:0xf bank_mask:0xf
v_and_b32_dpp v26, v20, v14 row_newbcast:4 row_mask:0xf bank_mask:0xf
v_and_b32_dpp v27, v20, v15 row_newbcast:4 row_mask:0xf bank_mask:0xf
s_nop 1
v_mfma_f32_16x16x32_bf16 v[28:31], v[24:27], v[128:131], v[28:31]
s_waitcnt vmcnt(6)
buffer_load_dwordx4 v[152:155], v5, s[36:39], s66 offen
s_add_u32 s66, s66, 0x40000
s_cmp_eq_u32 s66, 0x480000
s_cselect_b32 s66, 0, s66
s_waitcnt vmcnt(4)
buffer_load_dwordx4 v[156:159], v4, s[28:31], s64 offen nt
s_addk_i32 s64, 8192
s_lshr_b32 s70, s2, 2
s_cmp_lg_u32 s70, 62
s_cbranch_scc1 L_norace
s_and_b32 s69, s3, 1
s_lshl_b32 s69, s69, 13
s_add_u32 s68, s101, s69
s_memtime s[4:5]
s_waitcnt lgkmcnt(0)
s_load_dword s7, s[44:45], s68 glc
s_waitcnt lgkmcnt(0)
s_memtime s[6:7]
s_waitcnt lgkmcnt(0)
s_sub_u32 s4, s6, s4
v_mov_b32 v6, s4
ds_write_b32 v39, v6 offset:4416
s_waitcnt lgkmcnt(0)
L_norace:
s_barrier
s_cmp_lg_u32 s70, 62
s_cbranch_scc1 L_notab
v_mov_b32 v6, 0
ds_read_b128 v[40:43], v6 offset:4416
ds_read_b128 v[44:47], v6 offset:4432
s_waitcnt lgkmcnt(0)
v_min3_u32 v40, v40, v42, v44
v_min3_u32 v41, v41, v43, v45
v_min_u32 v40, v40, v46
v_min_u32 v41, v41, v47
v_cmp_lt_u32 vcc, v41, v40
s_nop 1
v_cndmask_b32 v40, 1, 9, vcc
L_notab:
s_lshl2_add_u32 s68, s60, 16
s_cmp_eq_u32 s70, 62
s_cselect_b32 s68, s68, 0x7ffffff0
v_cmp_eq_u32 vcc, 0, v0
v_mov_b32 v7, s68
s_nop 0
v_cndmask_b32 v7, v22, v7, vcc
buffer_store_dword v40, v7, s[56:59], 0 offen sc1
v_cmp_eq_u32 vcc, 0, v0
s_and_b32 s68, s2, 3
s_lshl_b32 s68, s68, 6
s_and_b32 s69, s2, 4
s_add_u32 s68, s68, s69
v_mov_b32 v8, s68
s_getreg_b32 s68, hwreg(HW_REG_XCC_ID, 0, 3)
v_cndmask_b32 v7, v22, v8, vcc
s_mul_i32 s69, s68, s68
s_lshl_b32 s69, s69, 10
s_add_u32 s68, s68, s69
s_lshl_b32 s68, s68, 8
s_add_u32 s68, s68, 1
v_mov_b32 v8, s68
buffer_atomic_add v8, v7, s[56:59], 0 offen sc1
s_waitcnt vmcnt(6)
buffer_load_dwordx4 v[160:163], v4, s[28:31], s64 offen nt
s_addk_i32 s64, 8192
v_and_b32_dpp v24, v20, v12 row_newbcast:5 row_mask:0xf bank_mask:0xf
v_and_b32_dpp v25, v20, v13 row_newbcast:5 row_mask:0xf bank_mask:0xf
v_and_b32_dpp v26, v20, v14 row_newbcast:5 row_mask:0xf bank_mask:0xf
v_and_b32_dpp v27, v20, v15 row_newbcast:5 row_mask:0xf bank_mask:0xf
s_nop 1
v_mfma_f32_16x16x32_bf16 v[28:31], v[24:27], v[140:143], v[28:31]
s_waitcnt vmcnt(6)
buffer_load_dwordx4 v[164:167], v5, s[36:39], s66 offen
s_add_u32 s66, s66, 0x40000
s_cmp_eq_u32 s66, 0x480000
s_cselect_b32 s66, 0, s66
s_waitcnt vmcnt(6)
buffer_load_dwordx4 v[168:171], v4, s[28:31], s64 offen nt
s_addk_i32 s64, 8192
s_waitcnt vmcnt(6)
buffer_load_dwordx4 v[172:175], v4, s[28:31], s64 offen nt
s_addk_i32 s64, 8192
v_and_b32_dpp v24, v20, v12 row_newbcast:6 row_mask:0xf bank_mask:0xf
v_and_b32_dpp v25, v20, v13 row_newbcast:6 row_mask:0xf bank_mask:0xf
v_and_b32_dpp v26, v20, v14 row_newbcast:6 row_mask:0xf bank_mask:0xf
v_and_b32_dpp v27, v20, v15 row_newbcast:6 row_mask:0xf bank_mask:0xf
s_nop 1
v_mfma_f32_16x16x32_bf16 v[28:31], v[24:27], v[152:155], v[28:31]
s_waitcnt vmcnt(6)
buffer_load_dwordx4 v[176:179], v5, s[36:39], s66 offen
s_add_u32 s66, s66, 0x40000
s_cmp_eq_u32 s66, 0x480000
s_cselect_b32 s66, 0, s66
s_waitcnt vmcnt(4)
buffer_load_dwordx4 v[180:183], v4, s[28:31], s64 offen nt
s_addk_i32 s64, 8192
s_waitcnt vmcnt(4)
buffer_load_dwordx4 v[184:187], v4, s[28:31], s64 offen nt
s_addk_i32 s64, 8192
v_and_b32_dpp v24, v20, v12 row_newbcast:7 row_mask:0xf bank_mask:0xf
v_and_b32_dpp v25, v20, v13 row_newbcast:7 row_mask:0xf bank_mask:0xf
v_and_b32_dpp v26, v20, v14 row_newbcast:7 row_mask:0xf bank_mask:0xf
v_and_b32_dpp v27, v20, v15 row_newbcast:7 row_mask:0xf bank_mask:0xf
s_nop 1
v_mfma_f32_16x16x32_bf16 v[28:31], v[24:27], v[164:167], v[28:31]
s_waitcnt vmcnt(4)
buffer_load_dwordx4 v[188:191], v5, s[36:39], s66 offen
s_add_u32 s66, s66, 0x40000
s_cmp_eq_u32 s66, 0x480000
s_cselect_b32 s66, 0, s66
s_waitcnt vmcnt(4)
buffer_load_dwordx4 v[192:195], v4, s[28:31], s64 offen nt
s_addk_i32 s64, 8192
s_waitcnt vmcnt(4)
buffer_load_dwordx4 v[196:199], v4, s[28:31], s64 offen nt
s_addk_i32 s64, 8192
v_and_b32_dpp v24, v20, v12 row_newbcast:8 row_mask:0xf bank_mask:0xf
v_and_b32_dpp v25, v20, v13 row_newbcast:8 row_mask:0xf bank_mask:0xf
v_and_b32_dpp v26, v20, v14 row_newbcast:8 row_mask:0xf bank_mask:0xf
v_and_b32_dpp v27, v20, v15 row_newbcast:8 row_mask:0xf bank_mask:0xf
s_nop 1
v_mfma_f32_16x16x32_bf16 v[28:31], v[24:27], v[176:179], v[28:31]
s_waitcnt vmcnt(4)
buffer_load_dwordx4 v[200:203], v5, s[36:39], s66 offen
s_add_u32 s66, s66, 0x40000
s_cmp_eq_u32 s66, 0x480000
s_cselect_b32 s66, 0, s66
s_waitcnt vmcnt(4)
buffer_load_dwordx4 v[204:207], v4, s[28:31], s64 offen nt
s_addk_i32 s64, 8192
s_waitcnt vmcnt(4)
buffer_load_dwordx4 v[208:211], v4, s[28:31], s64 offen nt
s_addk_i32 s64, 8192
v_and_b32_dpp v24, v20, v12 row_newbcast:9 row_mask:0xf bank_mask:0xf
v_and_b32_dpp v25, v20, v13 row_newbcast:9 row_mask:0xf bank_mask:0xf
v_and_b32_dpp v26, v20, v14 row_newbcast:9 row_mask:0xf bank_mask:0xf
v_and_b32_dpp v27, v20, v15 row_newbcast:9 row_mask:0xf bank_mask:0xf
s_nop 1
v_mfma_f32_16x16x32_bf16 v[28:31], v[24:27], v[188:191], v[28:31]
s_waitcnt vmcnt(4)
buffer_load_dwordx4 v[212:215], v5, s[36:39], s66 offen
s_add_u32 s66, s66, 0x40000
s_cmp_eq_u32 s66, 0x480000
s_cselect_b32 s66, 0, s66
s_waitcnt vmcnt(4)
buffer_load_dwordx4 v[216:219], v4, s[28:31], s64 offen nt
s_addk_i32 s64, 8192
s_waitcnt vmcnt(4)
buffer_load_dwordx4 v[220:223], v4, s[28:31], s64 offen nt
s_addk_i32 s64, 8192
v_and_b32_dpp v24, v20, v12 row_newbcast:10 row_mask:0xf bank_mask:0xf
v_and_b32_dpp v25, v20, v13 row_newbcast:10 row_mask:0xf bank_mask:0xf
v_and_b32_dpp v26, v20, v14 row_newbcast:10 row_mask:0xf bank_mask:0xf
v_and_b32_dpp v27, v20, v15 row_newbcast:10 row_mask:0xf bank_mask:0xf
s_nop 1
v_mfma_f32_16x16x32_bf16 v[28:31], v[24:27], v[200:203], v[28:31]
s_waitcnt vmcnt(4)
buffer_load_dwordx4 v[224:227], v5, s[36:39], s66 offen
s_add_u32 s66, s66, 0x40000
s_cmp_eq_u32 s66, 0x480000
s_cselect_b32 s66, 0, s66
s_waitcnt vmcnt(4)
buffer_load_dwordx4 v[228:231], v4, s[28:31], s64 offen nt
s_addk_i32 s64, 8192
s_waitcnt vmcnt(4)
buffer_load_dwordx4 v[232:235], v4, s[28:31], s64 offen nt
s_addk_i32 s64, 8192
v_and_b32_dpp v24, v20, v12 row_newbcast:11 row_mask:0xf bank_mask:0xf
v_and_b32_dpp v25, v20, v13 row_newbcast:11 row_mask:0xf bank_mask:0xf
v_and_b32_dpp v26, v20, v14 row_newbcast:11 row_mask:0xf bank_mask:0xf
v_and_b32_dpp v27, v20, v15 row_newbcast:11 row_mask:0xf bank_mask:0xf
s_nop 1
v_mfma_f32_16x16x32_bf16 v[28:31], v[24:27], v[212:215], v[28:31]
s_waitcnt vmcnt(4)
buffer_load_dwordx4 v[236:239], v5, s[36:39], s66 offen
s_add_u32 s66, s66, 0x40000
s_cmp_eq_u32 s66, 0x480000
s_cselect_b32 s66, 0, s66
s_waitcnt vmcnt(4)
buffer_load_dwordx4 v[80:83], v4, s[28:31], s64 offen nt
s_addk_i32 s64, 8192
s_waitcnt vmcnt(4)
buffer_load_dwordx4 v[92:95], v4, s[28:31], s64 offen nt
v_and_b32_dpp v24, v20, v12 row_newbcast:12 row_mask:0xf bank_mask:0xf
v_and_b32_dpp v25, v20, v13 row_newbcast:12 row_mask:0xf bank_mask:0xf
v_and_b32_dpp v26, v20, v14 row_newbcast:12 row_mask:0xf bank_mask:0xf
v_and_b32_dpp v27, v20, v15 row_newbcast:12 row_mask:0xf bank_mask:0xf
s_nop 1
v_mfma_f32_16x16x32_bf16 v[28:31], v[24:27], v[224:227], v[28:31]
s_waitcnt vmcnt(4)
buffer_load_dwordx4 v[104:107], v5, s[36:39], s66 offen
s_add_u32 s66, s66, 0x40000
s_cmp_eq_u32 s66, 0x480000
s_cselect_b32 s66, 0, s66
s_waitcnt vmcnt(4)
buffer_load_dwordx4 v[116:119], v5, s[36:39], s66 offen
s_add_u32 s66, s66, 0x40000
s_cmp_eq_u32 s66, 0x480000
s_cselect_b32 s66, 0, s66
s_waitcnt vmcnt(4)
buffer_load_dwordx4 v[128:131], v5, s[36:39], s66 offen
s_add_u32 s66, s66, 0x40000
s_cmp_eq_u32 s66, 0x480000
s_cselect_b32 s66, 0, s66
v_and_b32_dpp v24, v20, v12 row_newbcast:13 row_mask:0xf bank_mask:0xf
v_and_b32_dpp v25, v20, v13 row_newbcast:13 row_mask:0xf bank_mask:0xf
v_and_b32_dpp v26, v20, v14 row_newbcast:13 row_mask:0xf bank_mask:0xf
v_and_b32_dpp v27, v20, v15 row_newbcast:13 row_mask:0xf bank_mask:0xf
s_nop 1
v_mfma_f32_16x16x32_bf16 v[28:31], v[24:27], v[236:239], v[28:31]
s_waitcnt vmcnt(4)
buffer_load_dwordx4 v[140:143], v5, s[36:39], s66 offen
s_waitcnt vmcnt(4)
buffer_load_dwordx4 v[152:155], v4, s[32:35], s65 offen nt
s_addk_i32 s65, 8192
s_waitcnt vmcnt(4)
buffer_load_dwordx4 v[164:167], v4, s[32:35], s65 offen nt
s_addk_i32 s65, 8192
v_and_b32_dpp v24, v20, v12 row_newbcast:14 row_mask:0xf bank_mask:0xf
v_and_b32_dpp v25, v20, v13 row_newbcast:14 row_mask:0xf bank_mask:0xf
v_and_b32_dpp v26, v20, v14 row_newbcast:14 row_mask:0xf bank_mask:0xf
v_and_b32_dpp v27, v20, v15 row_newbcast:14 row_mask:0xf bank_mask:0xf
s_nop 1
v_mfma_f32_16x16x32_bf16 v[28:31], v[24:27], v[104:107], v[28:31]
s_waitcnt vmcnt(4)
buffer_load_dwordx4 v[176:179], v4, s[32:35], s65 offen nt
s_addk_i32 s65, 8192
v_and_b32_dpp v24, v20, v12 row_newbcast:15 row_mask:0xf bank_mask:0xf
v_and_b32_dpp v25, v20, v13 row_newbcast:15 row_mask:0xf bank_mask:0xf
v_and_b32_dpp v26, v20, v14 row_newbcast:15 row_mask:0xf bank_mask:0xf
v_and_b32_dpp v27, v20, v15 row_newbcast:15 row_mask:0xf bank_mask:0xf
s_nop 1
v_mfma_f32_16x16x32_bf16 v[28:31], v[24:27], v[116:119], v[28:31]
s_waitcnt vmcnt(4)
buffer_load_dwordx4 v[188:191], v4, s[32:35], s65 offen nt
s_addk_i32 s65, 8192
v_and_b32_dpp v24, v21, v12 row_newbcast:0 row_mask:0xf bank_mask:0xf
v_and_b32_dpp v25, v21, v13 row_newbcast:0 row_mask:0xf bank_mask:0xf
v_and_b32_dpp v26, v21, v14 row_newbcast:0 row_mask:0xf bank_mask:0xf
v_and_b32_dpp v27, v21, v15 row_newbcast:0 row_mask:0xf bank_mask:0xf
s_nop 1
v_mfma_f32_16x16x32_bf16 v[28:31], v[24:27], v[128:131], v[28:31]
s_waitcnt vmcnt(4)
buffer_load_dwordx4 v[200:203], v4, s[32:35], s65 offen nt
s_addk_i32 s65, 8192
v_and_b32_dpp v24, v21, v12 row_newbcast:1 row_mask:0xf bank_mask:0xf
v_and_b32_dpp v25, v21, v13 row_newbcast:1 row_mask:0xf bank_mask:0xf
v_and_b32_dpp v26, v21, v14 row_newbcast:1 row_mask:0xf bank_mask:0xf
v_and_b32_dpp v27, v21, v15 row_newbcast:1 row_mask:0xf bank_mask:0xf
s_nop 1
v_mfma_f32_16x16x32_bf16 v[28:31], v[24:27], v[140:143], v[28:31]
v_and_b32 v6, 3, v1
v_and_b32 v7, 4, v1
v_lshl_add_u32 v5, v6, 6, v7
v_mov_b32 v56, 32
v_and_b32 v7, 8, v1
v_cmp_ne_u32 vcc, 0, v7
v_lshl_add_u32 v6, v6, 2, 16
s_nop 0
v_cndmask_b32 v5, v5, v6, vcc
v_cndmask_b32 v56, v56, 1, vcc
buffer_load_dword v34, v5, s[56:59], 0 offen sc1
buffer_load_dwordx4 v[212:215], v4, s[32:35], s65 offen nt
s_addk_i32 s65, 8192
ds_write_b128 v38, v[28:31] offset:0
v_mov_b32 v40, 0
v_mov_b32 v41, 0
v_mov_b32 v42, 0
v_mov_b32 v43, 0
v_mov_b32 v44, 0
v_mov_b32 v45, 0
v_mov_b32 v46, 0
v_mov_b32 v47, 0
v_mov_b32 v48, 0
v_mov_b32 v49, 0
v_mov_b32 v50, 0
v_mov_b32 v51, 0
v_mov_b32 v52, 0
v_mov_b32 v53, 0
v_mov_b32 v54, 0
v_mov_b32 v55, 0
s_waitcnt lgkmcnt(0)
s_barrier
s_cmp_lg_u32 s3, 0
s_cbranch_scc1 L_q2
ds_read_b64 v[240:241], v11 offset:0
ds_read_b64 v[242:243], v11 offset:512
ds_read_b64 v[244:245], v11 offset:1024
ds_read_b64 v[246:247], v11 offset:1536
ds_read_b64 v[248:249], v11 offset:2048
ds_read_b64 v[250:251], v11 offset:2560
ds_read_b64 v[252:253], v11 offset:3072
ds_read_b64 v[254:255], v11 offset:3584
s_waitcnt lgkmcnt(0)
v_add_f32 v240, v240, v242
v_add_f32 v241, v241, v243
v_add_f32 v244, v244, v246
v_add_f32 v245, v245, v247
v_add_f32 v248, v248, v250
v_add_f32 v249, v249, v251
v_add_f32 v252, v252, v254
v_add_f32 v253, v253, v255
v_add_f32 v240, v240, v244
v_add_f32 v241, v241, v245
v_add_f32 v248, v248, v252
v_add_f32 v249, v249, v253
v_add_f32 v240, v240, v248
v_add_f32 v241, v241, v249
v_cvt_pk_bf16_f32 v7, v240, v241
v_lshlrev_b32 v6, 2, v1
ds_write_b32 v6, v7 offset:4096
s_waitcnt lgkmcnt(0)
L_q2:
s_barrier
v_lshlrev_b32 v6, 4, v3
ds_read_b128 v[16:19], v6 offset:4096
s_waitcnt lgkmcnt(0)
v_dot2c_f32_bf16 v40, v64, v16
v_dot2c_f32_bf16 v40, v65, v17
v_dot2c_f32_bf16 v40, v66, v18
v_dot2c_f32_bf16 v40, v67, v19
v_dot2c_f32_bf16 v41, v68, v16
v_dot2c_f32_bf16 v41, v69, v17
v_dot2c_f32_bf16 v41, v70, v18
v_dot2c_f32_bf16 v41, v71, v19
v_dot2c_f32_bf16 v42, v72, v16
v_dot2c_f32_bf16 v42, v73, v17
v_dot2c_f32_bf16 v42, v74, v18
v_dot2c_f32_bf16 v42, v75, v19
v_dot2c_f32_bf16 v43, v76, v16
v_dot2c_f32_bf16 v43, v77, v17
v_dot2c_f32_bf16 v43, v78, v18
v_dot2c_f32_bf16 v43, v79, v19
v_dot2c_f32_bf16 v44, v84, v16
v_dot2c_f32_bf16 v44, v85, v17
v_dot2c_f32_bf16 v44, v86, v18
v_dot2c_f32_bf16 v44, v87, v19
v_dot2c_f32_bf16 v45, v88, v16
v_dot2c_f32_bf16 v45, v89, v17
v_dot2c_f32_bf16 v45, v90, v18
v_dot2c_f32_bf16 v45, v91, v19
s_waitcnt vmcnt(4)
buffer_load_dwordx4 v[224:227], v4, s[32:35], s65 offen nt
s_addk_i32 s65, 8192
v_dot2c_f32_bf16 v46, v96, v16
v_dot2c_f32_bf16 v46, v97, v17
v_dot2c_f32_bf16 v46, v98, v18
v_dot2c_f32_bf16 v46, v99, v19
v_dot2c_f32_bf16 v47, v100, v16
v_dot2c_f32_bf16 v47, v101, v17
v_dot2c_f32_bf16 v47, v102, v18
v_dot2c_f32_bf16 v47, v103, v19
v_dot2c_f32_bf16 v48, v108, v16
v_dot2c_f32_bf16 v48, v109, v17
v_dot2c_f32_bf16 v48, v110, v18
v_dot2c_f32_bf16 v48, v111, v19
v_dot2c_f32_bf16 v49, v112, v16
v_dot2c_f32_bf16 v49, v113, v17
v_dot2c_f32_bf16 v49, v114, v18
v_dot2c_f32_bf16 v49, v115, v19
v_dot2c_f32_bf16 v50, v120, v16
v_dot2c_f32_bf16 v50, v121, v17
v_dot2c_f32_bf16 v50, v122, v18
v_dot2c_f32_bf16 v50, v123, v19
v_dot2c_f32_bf16 v51, v124, v16
v_dot2c_f32_bf16 v51, v125, v17
v_dot2c_f32_bf16 v51, v126, v18
v_dot2c_f32_bf16 v51, v127, v19
s_waitcnt vmcnt(4)
buffer_load_dwordx4 v[236:239], v4, s[32:35], s65 offen nt
s_addk_i32 s65, 8192
v_dot2c_f32_bf16 v52, v132, v16
v_dot2c_f32_bf16 v52, v133, v17
v_dot2c_f32_bf16 v52, v134, v18
v_dot2c_f32_bf16 v52, v135, v19
v_dot2c_f32_bf16 v53, v136, v16
v_dot2c_f32_bf16 v53, v137, v17
v_dot2c_f32_bf16 v53, v138, v18
v_dot2c_f32_bf16 v53, v139, v19
v_dot2c_f32_bf16 v54, v144, v16
v_dot2c_f32_bf16 v54, v145, v17
v_dot2c_f32_bf16 v54, v146, v18
v_dot2c_f32_bf16 v54, v147, v19
v_dot2c_f32_bf16 v55, v148, v16
v_dot2c_f32_bf16 v55, v149, v17
v_dot2c_f32_bf16 v55, v150, v18
v_dot2c_f32_bf16 v55, v151, v19
v_add_f32_dpp v40, v40, v40 row_ror:8 row_mask:0xf bank_mask:0x3
v_add_f32_dpp v41, v41, v41 row_ror:8 row_mask:0xf bank_mask:0x3
v_add_f32_dpp v42, v42, v42 row_ror:8 row_mask:0xf bank_mask:0x3
v_add_f32_dpp v43, v43, v43 row_ror:8 row_mask:0xf bank_mask:0x3
v_add_f32_dpp v44, v44, v44 row_ror:8 row_mask:0xf bank_mask:0x3
v_add_f32_dpp v45, v45, v45 row_ror:8 row_mask:0xf bank_mask:0x3
v_add_f32_dpp v46, v46, v46 row_ror:8 row_mask:0xf bank_mask:0x3
v_add_f32_dpp v47, v47, v47 row_ror:8 row_mask:0xf bank_mask:0x3
v_add_f32_dpp v40, v48, v48 row_ror:8 row_mask:0xf bank_mask:0xc
v_add_f32_dpp v41, v49, v49 row_ror:8 row_mask:0xf bank_mask:0xc
v_add_f32_dpp v42, v50, v50 row_ror:8 row_mask:0xf bank_mask:0xc
v_add_f32_dpp v43, v51, v51 row_ror:8 row_mask:0xf bank_mask:0xc
v_add_f32_dpp v44, v52, v52 row_ror:8 row_mask:0xf bank_mask:0xc
v_add_f32_dpp v45, v53, v53 row_ror:8 row_mask:0xf bank_mask:0xc
v_add_f32_dpp v46, v54, v54 row_ror:8 row_mask:0xf bank_mask:0xc
v_add_f32_dpp v47, v55, v55 row_ror:8 row_mask:0xf bank_mask:0xc
v_add_f32_dpp v40, v40, v40 row_shl:4 row_mask:0xf bank_mask:0x5
v_add_f32_dpp v41, v41, v41 row_shl:4 row_mask:0xf bank_mask:0x5
v_add_f32_dpp v42, v42, v42 row_shl:4 row_mask:0xf bank_mask:0x5
v_add_f32_dpp v43, v43, v43 row_shl:4 row_mask:0xf bank_mask:0x5
v_add_f32_dpp v40, v44, v44 row_shr:4 row_mask:0xf bank_mask:0xa
v_add_f32_dpp v41, v45, v45 row_shr:4 row_mask:0xf bank_mask:0xa
v_add_f32_dpp v42, v46, v46 row_shr:4 row_mask:0xf bank_mask:0xa
v_add_f32_dpp v43, v47, v47 row_shr:4 row_mask:0xf bank_mask:0xa
v_cndmask_b32 v48, v40, v42, s[74:75]
v_cndmask_b32 v50, v42, v40, s[74:75]
v_cndmask_b32 v49, v41, v43, s[74:75]
v_cndmask_b32 v51, v43, v41, s[74:75]
v_add_f32_dpp v40, v50, v48 quad_perm:[2,3,0,1] row_mask:0xf bank_mask:0xf
s_nop 0
v_add_f32_dpp v41, v51, v49 quad_perm:[2,3,0,1] row_mask:0xf bank_mask:0xf
v_cndmask_b32 v48, v40, v41, s[72:73]
v_cndmask_b32 v49, v41, v40, s[72:73]
s_nop 1
v_add_f32_dpp v32, v49, v48 quad_perm:[1,0,3,2] row_mask:0xf bank_mask:0xf
v_mov_b32 v40, 0
v_mov_b32 v41, 0
v_mov_b32 v42, 0
v_mov_b32 v43, 0
v_mov_b32 v44, 0
v_mov_b32 v45, 0
v_mov_b32 v46, 0
v_mov_b32 v47, 0
v_mov_b32 v48, 0
v_mov_b32 v49, 0
v_mov_b32 v50, 0
v_mov_b32 v51, 0
v_mov_b32 v52, 0
v_mov_b32 v53, 0
v_mov_b32 v54, 0
v_mov_b32 v55, 0
v_dot2c_f32_bf16 v40, v156, v16
v_dot2c_f32_bf16 v40, v157, v17
v_dot2c_f32_bf16 v40, v158, v18
v_dot2c_f32_bf16 v40, v159, v19
v_dot2c_f32_bf16 v41, v160, v16
v_dot2c_f32_bf16 v41, v161, v17
v_dot2c_f32_bf16 v41, v162, v18
v_dot2c_f32_bf16 v41, v163, v19
s_waitcnt vmcnt(4)
buffer_load_dwordx4 v[104:107], v4, s[32:35], s65 offen nt
s_addk_i32 s65, 8192
v_dot2c_f32_bf16 v42, v168, v16
v_dot2c_f32_bf16 v42, v169, v17
v_dot2c_f32_bf16 v42, v170, v18
v_dot2c_f32_bf16 v42, v171, v19
v_dot2c_f32_bf16 v43, v172, v16
v_dot2c_f32_bf16 v43, v173, v17
v_dot2c_f32_bf16 v43, v174, v18
v_dot2c_f32_bf16 v43, v175, v19
v_dot2c_f32_bf16 v44, v180, v16
v_dot2c_f32_bf16 v44, v181, v17
v_dot2c_f32_bf16 v44, v182, v18
v_dot2c_f32_bf16 v44, v183, v19
v_dot2c_f32_bf16 v45, v184, v16
v_dot2c_f32_bf16 v45, v185, v17
v_dot2c_f32_bf16 v45, v186, v18
v_dot2c_f32_bf16 v45, v187, v19
v_dot2c_f32_bf16 v46, v192, v16
v_dot2c_f32_bf16 v46, v193, v17
v_dot2c_f32_bf16 v46, v194, v18
v_dot2c_f32_bf16 v46, v195, v19
v_dot2c_f32_bf16 v47, v196, v16
v_dot2c_f32_bf16 v47, v197, v17
v_dot2c_f32_bf16 v47, v198, v18
v_dot2c_f32_bf16 v47, v199, v19
s_waitcnt vmcnt(3)
buffer_load_dwordx4 v[116:119], v4, s[32:35], s65 offen nt
s_addk_i32 s65, 8192
v_dot2c_f32_bf16 v48, v204, v16
v_dot2c_f32_bf16 v48, v205, v17
v_dot2c_f32_bf16 v48, v206, v18
v_dot2c_f32_bf16 v48, v207, v19
v_dot2c_f32_bf16 v49, v208, v16
v_dot2c_f32_bf16 v49, v209, v17
v_dot2c_f32_bf16 v49, v210, v18
v_dot2c_f32_bf16 v49, v211, v19
v_dot2c_f32_bf16 v50, v216, v16
v_dot2c_f32_bf16 v50, v217, v17
v_dot2c_f32_bf16 v50, v218, v18
v_dot2c_f32_bf16 v50, v219, v19
v_dot2c_f32_bf16 v51, v220, v16
v_dot2c_f32_bf16 v51, v221, v17
v_dot2c_f32_bf16 v51, v222, v18
v_dot2c_f32_bf16 v51, v223, v19
v_dot2c_f32_bf16 v52, v228, v16
v_dot2c_f32_bf16 v52, v229, v17
v_dot2c_f32_bf16 v52, v230, v18
v_dot2c_f32_bf16 v52, v231, v19
v_dot2c_f32_bf16 v53, v232, v16
v_dot2c_f32_bf16 v53, v233, v17
v_dot2c_f32_bf16 v53, v234, v18
v_dot2c_f32_bf16 v53, v235, v19
s_waitcnt vmcnt(3)
buffer_load_dwordx4 v[128:131], v4, s[32:35], s65 offen nt
s_addk_i32 s65, 8192
v_dot2c_f32_bf16 v54, v80, v16
v_dot2c_f32_bf16 v54, v81, v17
v_dot2c_f32_bf16 v54, v82, v18
v_dot2c_f32_bf16 v54, v83, v19
v_dot2c_f32_bf16 v55, v92, v16
v_dot2c_f32_bf16 v55, v93, v17
v_dot2c_f32_bf16 v55, v94, v18
v_dot2c_f32_bf16 v55, v95, v19
buffer_load_dwordx4 v[140:143], v4, s[32:35], s65 offen nt
s_addk_i32 s65, 8192
v_add_f32_dpp v40, v40, v40 row_ror:8 row_mask:0xf bank_mask:0x3
v_add_f32_dpp v41, v41, v41 row_ror:8 row_mask:0xf bank_mask:0x3
v_add_f32_dpp v42, v42, v42 row_ror:8 row_mask:0xf bank_mask:0x3
v_add_f32_dpp v43, v43, v43 row_ror:8 row_mask:0xf bank_mask:0x3
v_add_f32_dpp v44, v44, v44 row_ror:8 row_mask:0xf bank_mask:0x3
v_add_f32_dpp v45, v45, v45 row_ror:8 row_mask:0xf bank_mask:0x3
v_add_f32_dpp v46, v46, v46 row_ror:8 row_mask:0xf bank_mask:0x3
v_add_f32_dpp v47, v47, v47 row_ror:8 row_mask:0xf bank_mask:0x3
v_add_f32_dpp v40, v48, v48 row_ror:8 row_mask:0xf bank_mask:0xc
v_add_f32_dpp v41, v49, v49 row_ror:8 row_mask:0xf bank_mask:0xc
v_add_f32_dpp v42, v50, v50 row_ror:8 row_mask:0xf bank_mask:0xc
v_add_f32_dpp v43, v51, v51 row_ror:8 row_mask:0xf bank_mask:0xc
v_add_f32_dpp v44, v52, v52 row_ror:8 row_mask:0xf bank_mask:0xc
v_add_f32_dpp v45, v53, v53 row_ror:8 row_mask:0xf bank_mask:0xc
v_add_f32_dpp v46, v54, v54 row_ror:8 row_mask:0xf bank_mask:0xc
v_add_f32_dpp v47, v55, v55 row_ror:8 row_mask:0xf bank_mask:0xc
v_add_f32_dpp v40, v40, v40 row_shl:4 row_mask:0xf bank_mask:0x5
v_add_f32_dpp v41, v41, v41 row_shl:4 row_mask:0xf bank_mask:0x5
v_add_f32_dpp v42, v42, v42 row_shl:4 row_mask:0xf bank_mask:0x5
v_add_f32_dpp v43, v43, v43 row_shl:4 row_mask:0xf bank_mask:0x5
v_add_f32_dpp v40, v44, v44 row_shr:4 row_mask:0xf bank_mask:0xa
v_add_f32_dpp v41, v45, v45 row_shr:4 row_mask:0xf bank_mask:0xa
v_add_f32_dpp v42, v46, v46 row_shr:4 row_mask:0xf bank_mask:0xa
v_add_f32_dpp v43, v47, v47 row_shr:4 row_mask:0xf bank_mask:0xa
v_cndmask_b32 v48, v40, v42, s[74:75]
v_cndmask_b32 v50, v42, v40, s[74:75]
v_cndmask_b32 v49, v41, v43, s[74:75]
v_cndmask_b32 v51, v43, v41, s[74:75]
v_add_f32_dpp v40, v50, v48 quad_perm:[2,3,0,1] row_mask:0xf bank_mask:0xf
s_nop 0
v_add_f32_dpp v41, v51, v49 quad_perm:[2,3,0,1] row_mask:0xf bank_mask:0xf
v_cndmask_b32 v48, v40, v41, s[72:73]
v_cndmask_b32 v49, v41, v40, s[72:73]
s_nop 1
v_add_f32_dpp v33, v49, v48 quad_perm:[1,0,3,2] row_mask:0xf bank_mask:0xf
L_cnt:
v_and_b32 v6, 0xff, v34
v_cmp_gt_u32 vcc, v56, v6
s_cbranch_vccz L_cntok
buffer_load_dword v34, v5, s[56:59], 0 offen sc1
s_waitcnt vmcnt(0)
s_sub_u32 s71, s71, 1
s_cbranch_scc0 L_cnt
s_mov_b32 s71, 0
L_cntok:
v_readlane_b32 s68, v34, s60
s_nop 0
s_bfe_u32 s69, s68, 0xa0008
s_lshr_b32 s68, s68, 18
s_mul_i32 s69, s69, s69
s_lshl_b32 s68, s68, 5
s_cmp_eq_u32 s68, s69
s_cselect_b32 s77, 1, 0
v_cmp_lt_u32 vcc, 5, v34
s_nop 0
s_bfe_u32 s100, vcc_lo, 0x40008
s_xor_b32 s68, s100, 15
s_lshl4_add_u32 s100, s68, s100
s_lshr_b32 s78, s100, s60
s_and_b32 s78, s78, 1
s_lshl_b32 s78, s78, 13
s_mov_b32 s69, 0x3db504f3
v_cvt_pk_bf16_f32 v32, v32, v32
v_and_b32 v32, 0xffff0000, v32
v_cvt_pk_bf16_f32 v33, v33, v33
v_and_b32 v33, 0xffff0000, v33
v_mul_f32 v32, s69, v32
v_mul_f32 v33, s69, v33
v_cvt_pk_bf16_f32 v32, v32, v32
v_and_b32 v32, 0xffff0000, v32
v_cvt_pk_bf16_f32 v33, v33, v33
v_and_b32 v33, 0xffff0000, v33
v_max_f32 v6, v32, v33
s_nop 1
v_max_f32_dpp v6, v6, v6 row_ror:8 row_mask:0xf bank_mask:0xf
s_nop 1
v_max_f32_dpp v6, v6, v6 row_ror:4 row_mask:0xf bank_mask:0xf
s_nop 1
v_max_f32_dpp v6, v6, v6 row_ror:2 row_mask:0xf bank_mask:0xf
s_nop 1
v_max_f32_dpp v6, v6, v6 row_ror:1 row_mask:0xf bank_mask:0xf
s_nop 1
v_max_f32_dpp v6, v6, v6 row_bcast:15 row_mask:0xa bank_mask:0xf
s_nop 1
v_max_f32_dpp v6, v6, v6 row_bcast:31 row_mask:0xc bank_mask:0xf
s_nop 0
v_readlane_b32 s68, v6, 63
s_nop 1
v_mov_b32 v6, s68
ds_write_b32 v39, v6 offset:4352
s_waitcnt lgkmcnt(0)
s_barrier
v_mov_b32 v6, 0
ds_read_b128 v[40:43], v6 offset:4352
ds_read_b128 v[44:47], v6 offset:4368
s_waitcnt lgkmcnt(0)
v_max3_f32 v37, v40, v41, v42
v_max3_f32 v37, v37, v43, v44
v_max3_f32 v37, v37, v45, v46
v_max_f32 v37, v37, v47
s_mov_b32 s69, 0x3fb8aa3b
v_sub_f32 v32, v32, v37
v_sub_f32 v33, v33, v37
v_mul_f32 v32, s69, v32
v_mul_f32 v33, s69, v33
v_exp_f32 v32, v32
v_exp_f32 v33, v33
s_waitcnt vmcnt(3)
buffer_load_dwordx4 v[64:67], v4, s[32:35], s65 offen nt
s_addk_i32 s65, 8192
v_cvt_pk_bf16_f32 v20, v32, v32
v_cvt_pk_bf16_f32 v21, v33, v33
v_add_f32 v6, v32, v33
s_nop 1
v_add_f32_dpp v6, v6, v6 row_ror:8 row_mask:0xf bank_mask:0xf
s_nop 1
v_add_f32_dpp v6, v6, v6 row_ror:4 row_mask:0xf bank_mask:0xf
s_nop 1
v_add_f32_dpp v6, v6, v6 row_ror:2 row_mask:0xf bank_mask:0xf
s_nop 1
v_add_f32_dpp v6, v6, v6 row_ror:1 row_mask:0xf bank_mask:0xf
s_nop 1
v_add_f32_dpp v6, v6, v6 row_bcast:15 row_mask:0xa bank_mask:0xf
s_nop 1
v_add_f32_dpp v6, v6, v6 row_bcast:31 row_mask:0xc bank_mask:0xf
s_nop 0
v_readlane_b32 s68, v6, 63
s_nop 1
v_mov_b32 v6, s68
ds_write_b32 v39, v6 offset:4384
v_and_b32_dpp v24, v20, v12 row_newbcast:0 row_mask:0xf bank_mask:0xf
v_and_b32_dpp v25, v20, v13 row_newbcast:0 row_mask:0xf bank_mask:0xf
v_and_b32_dpp v26, v20, v14 row_newbcast:0 row_mask:0xf bank_mask:0xf
v_and_b32_dpp v27, v20, v15 row_newbcast:0 row_mask:0xf bank_mask:0xf
s_nop 1
v_mfma_f32_16x16x32_bf16 v[28:31], v[24:27], v[152:155], 0
v_and_b32_dpp v24, v20, v12 row_newbcast:1 row_mask:0xf bank_mask:0xf
v_and_b32_dpp v25, v20, v13 row_newbcast:1 row_mask:0xf bank_mask:0xf
v_and_b32_dpp v26, v20, v14 row_newbcast:1 row_mask:0xf bank_mask:0xf
v_and_b32_dpp v27, v20, v15 row_newbcast:1 row_mask:0xf bank_mask:0xf
s_nop 1
v_mfma_f32_16x16x32_bf16 v[28:31], v[24:27], v[164:167], v[28:31]
v_lshrrev_b32 v6, 3, v1
v_lshlrev_b32 v6, 9, v6
v_and_b32 v7, 7, v1
v_lshl_add_u32 v6, v7, 4, v6
s_and_b32 s68, s3, 3
s_lshl_b32 s68, s68, 7
v_add_u32 v32, s68, v6
s_mov_b32 s14, 4718592
s_mov_b32 s15, 0x20000
s_mov_b32 s48, s16
s_mov_b32 s49, s17
s_mov_b32 s50, 5308416
s_mov_b32 s51, 0x20000
s_mov_b32 s8, s18
s_mov_b32 s9, s19
s_mov_b32 s10, 5308416
s_mov_b32 s11, 0x20000
s_mov_b32 s52, s20
s_mov_b32 s53, s21
s_mov_b32 s54, 5308416
s_mov_b32 s55, 0x20000
s_mov_b32 s24, s22
s_mov_b32 s25, s23
s_mov_b32 s26, 1152
s_mov_b32 s27, 0x20000
s_add_u32 s68, s61, 2
s_lshr_b32 s68, s68, 2
s_sub_u32 s68, s61, s68
s_lshl3_add_u32 s68, s68, s3
s_mul_i32 s101, s68, 3072
s_mul_i32 s69, s60, 589824
s_add_u32 s101, s101, s69
s_mul_i32 s66, s68, 27648
s_mul_i32 s69, s60, 1152
s_add_u32 s66, s66, s69
s_and_b32 s69, s61, 3
s_cmp_eq_u32 s69, 1
s_cselect_b32 s68, 0, 24
s_cselect_b32 s69, 0, 27
v_cmp_gt_u32 vcc, s68, v1
v_lshlrev_b32 v6, 7, v1
v_mul_u32_u24 v7, 57, v1
v_cndmask_b32 v54, v22, v6, vcc
v_lshrrev_b32 v7, 9, v7
v_cmp_gt_u32 vcc, s69, v1
v_mul_u32_u24 v7, 8064, v7
v_add_u32 v6, v6, v7
v_cndmask_b32 v55, v22, v6, vcc
v_and_b32_dpp v24, v20, v12 row_newbcast:2 row_mask:0xf bank_mask:0xf
v_and_b32_dpp v25, v20, v13 row_newbcast:2 row_mask:0xf bank_mask:0xf
v_and_b32_dpp v26, v20, v14 row_newbcast:2 row_mask:0xf bank_mask:0xf
v_and_b32_dpp v27, v20, v15 row_newbcast:2 row_mask:0xf bank_mask:0xf
s_nop 1
v_mfma_f32_16x16x32_bf16 v[28:31], v[24:27], v[176:179], v[28:31]
v_and_b32_dpp v24, v20, v12 row_newbcast:3 row_mask:0xf bank_mask:0xf
v_and_b32_dpp v25, v20, v13 row_newbcast:3 row_mask:0xf bank_mask:0xf
v_and_b32_dpp v26, v20, v14 row_newbcast:3 row_mask:0xf bank_mask:0xf
v_and_b32_dpp v27, v20, v15 row_newbcast:3 row_mask:0xf bank_mask:0xf
s_nop 1
v_mfma_f32_16x16x32_bf16 v[28:31], v[24:27], v[188:191], v[28:31]
v_and_b32_dpp v24, v20, v12 row_newbcast:4 row_mask:0xf bank_mask:0xf
v_and_b32_dpp v25, v20, v13 row_newbcast:4 row_mask:0xf bank_mask:0xf
v_and_b32_dpp v26, v20, v14 row_newbcast:4 row_mask:0xf bank_mask:0xf
v_and_b32_dpp v27, v20, v15 row_newbcast:4 row_mask:0xf bank_mask:0xf
s_nop 1
v_mfma_f32_16x16x32_bf16 v[28:31], v[24:27], v[200:203], v[28:31]
v_and_b32_dpp v24, v20, v12 row_newbcast:5 row_mask:0xf bank_mask:0xf
v_and_b32_dpp v25, v20, v13 row_newbcast:5 row_mask:0xf bank_mask:0xf
v_and_b32_dpp v26, v20, v14 row_newbcast:5 row_mask:0xf bank_mask:0xf
v_and_b32_dpp v27, v20, v15 row_newbcast:5 row_mask:0xf bank_mask:0xf
s_nop 1
v_mfma_f32_16x16x32_bf16 v[28:31], v[24:27], v[212:215], v[28:31]
s_waitcnt vmcnt(3)
buffer_load_dwordx4 v[68:71], v4, s[32:35], s65 offen nt
s_addk_i32 s65, 8192
v_and_b32_dpp v24, v20, v12 row_newbcast:6 row_mask:0xf bank_mask:0xf
v_and_b32_dpp v25, v20, v13 row_newbcast:6 row_mask:0xf bank_mask:0xf
v_and_b32_dpp v26, v20, v14 row_newbcast:6 row_mask:0xf bank_mask:0xf
v_and_b32_dpp v27, v20, v15 row_newbcast:6 row_mask:0xf bank_mask:0xf
s_nop 1
v_mfma_f32_16x16x32_bf16 v[28:31], v[24:27], v[224:227], v[28:31]
v_and_b32_dpp v24, v20, v12 row_newbcast:7 row_mask:0xf bank_mask:0xf
v_and_b32_dpp v25, v20, v13 row_newbcast:7 row_mask:0xf bank_mask:0xf
v_and_b32_dpp v26, v20, v14 row_newbcast:7 row_mask:0xf bank_mask:0xf
v_and_b32_dpp v27, v20, v15 row_newbcast:7 row_mask:0xf bank_mask:0xf
s_nop 1
v_mfma_f32_16x16x32_bf16 v[28:31], v[24:27], v[236:239], v[28:31]
v_and_b32_dpp v24, v20, v12 row_newbcast:8 row_mask:0xf bank_mask:0xf
v_and_b32_dpp v25, v20, v13 row_newbcast:8 row_mask:0xf bank_mask:0xf
v_and_b32_dpp v26, v20, v14 row_newbcast:8 row_mask:0xf bank_mask:0xf
v_and_b32_dpp v27, v20, v15 row_newbcast:8 row_mask:0xf bank_mask:0xf
s_nop 1
v_mfma_f32_16x16x32_bf16 v[28:31], v[24:27], v[104:107], v[28:31]
v_and_b32_dpp v24, v20, v12 row_newbcast:9 row_mask:0xf bank_mask:0xf
v_and_b32_dpp v25, v20, v13 row_newbcast:9 row_mask:0xf bank_mask:0xf
v_and_b32_dpp v26, v20, v14 row_newbcast:9 row_mask:0xf bank_mask:0xf
v_and_b32_dpp v27, v20, v15 row_newbcast:9 row_mask:0xf bank_mask:0xf
s_nop 1
v_mfma_f32_16x16x32_bf16 v[28:31], v[24:27], v[116:119], v[28:31]
s_waitcnt vmcnt(3)
buffer_load_dwordx4 v[72:75], v4, s[32:35], s65 offen nt
s_addk_i32 s65, 8192
v_and_b32_dpp v24, v20, v12 row_newbcast:10 row_mask:0xf bank_mask:0xf
v_and_b32_dpp v25, v20, v13 row_newbcast:10 row_mask:0xf bank_mask:0xf
v_and_b32_dpp v26, v20, v14 row_newbcast:10 row_mask:0xf bank_mask:0xf
v_and_b32_dpp v27, v20, v15 row_newbcast:10 row_mask:0xf bank_mask:0xf
s_nop 1
v_mfma_f32_16x16x32_bf16 v[28:31], v[24:27], v[128:131], v[28:31]
s_waitcnt vmcnt(3)
buffer_load_dwordx4 v[76:79], v4, s[32:35], s65 offen nt
s_addk_i32 s65, 8192
v_and_b32_dpp v24, v20, v12 row_newbcast:11 row_mask:0xf bank_mask:0xf
v_and_b32_dpp v25, v20, v13 row_newbcast:11 row_mask:0xf bank_mask:0xf
v_and_b32_dpp v26, v20, v14 row_newbcast:11 row_mask:0xf bank_mask:0xf
v_and_b32_dpp v27, v20, v15 row_newbcast:11 row_mask:0xf bank_mask:0xf
s_nop 1
v_mfma_f32_16x16x32_bf16 v[28:31], v[24:27], v[140:143], v[28:31]
s_waitcnt vmcnt(3)
buffer_load_dwordx4 v[84:87], v4, s[32:35], s65 offen nt
s_addk_i32 s65, 8192
v_and_b32_dpp v24, v20, v12 row_newbcast:12 row_mask:0xf bank_mask:0xf
v_and_b32_dpp v25, v20, v13 row_newbcast:12 row_mask:0xf bank_mask:0xf
v_and_b32_dpp v26, v20, v14 row_newbcast:12 row_mask:0xf bank_mask:0xf
v_and_b32_dpp v27, v20, v15 row_newbcast:12 row_mask:0xf bank_mask:0xf
s_nop 1
v_mfma_f32_16x16x32_bf16 v[28:31], v[24:27], v[64:67], v[28:31]
buffer_load_dwordx4 v[88:91], v4, s[32:35], s65 offen nt
s_addk_i32 s65, 8192
s_waitcnt lgkmcnt(0)
s_barrier
v_mov_b32 v6, 0
ds_read_b128 v[240:243], v6 offset:4384
ds_read_b128 v[244:247], v6 offset:4400
v_min_u32 v8, -2, v37
s_waitcnt lgkmcnt(0)
v_add_f32 v240, v240, v244
v_add_f32 v241, v241, v245
v_add_f32 v242, v242, v246
v_add_f32 v243, v243, v247
v_add_f32 v240, v240, v241
v_add_f32 v242, v242, v243
v_add_f32 v9, v240, v242
v_min_u32 v9, -2, v9
buffer_store_dwordx2 v[8:9], v23, s[44:47], s78 offen sc1
s_waitcnt vmcnt(4)
buffer_load_dwordx4 v[96:99], v4, s[32:35], s65 offen nt
s_addk_i32 s65, 8192
v_and_b32_dpp v24, v20, v12 row_newbcast:13 row_mask:0xf bank_mask:0xf
v_and_b32_dpp v25, v20, v13 row_newbcast:13 row_mask:0xf bank_mask:0xf
v_and_b32_dpp v26, v20, v14 row_newbcast:13 row_mask:0xf bank_mask:0xf
v_and_b32_dpp v27, v20, v15 row_newbcast:13 row_mask:0xf bank_mask:0xf
s_nop 1
v_mfma_f32_16x16x32_bf16 v[28:31], v[24:27], v[68:71], v[28:31]
v_and_b32_dpp v24, v20, v12 row_newbcast:14 row_mask:0xf bank_mask:0xf
v_and_b32_dpp v25, v20, v13 row_newbcast:14 row_mask:0xf bank_mask:0xf
v_and_b32_dpp v26, v20, v14 row_newbcast:14 row_mask:0xf bank_mask:0xf
v_and_b32_dpp v27, v20, v15 row_newbcast:14 row_mask:0xf bank_mask:0xf
s_nop 1
v_mfma_f32_16x16x32_bf16 v[28:31], v[24:27], v[72:75], v[28:31]
s_waitcnt vmcnt(4)
buffer_load_dwordx4 v[100:103], v4, s[32:35], s65 offen nt
s_addk_i32 s65, 8192
v_and_b32_dpp v24, v20, v12 row_newbcast:15 row_mask:0xf bank_mask:0xf
v_and_b32_dpp v25, v20, v13 row_newbcast:15 row_mask:0xf bank_mask:0xf
v_and_b32_dpp v26, v20, v14 row_newbcast:15 row_mask:0xf bank_mask:0xf
v_and_b32_dpp v27, v20, v15 row_newbcast:15 row_mask:0xf bank_mask:0xf
s_nop 1
v_mfma_f32_16x16x32_bf16 v[28:31], v[24:27], v[76:79], v[28:31]
s_waitcnt vmcnt(4)
buffer_load_dwordx4 v[108:111], v4, s[32:35], s65 offen nt
s_addk_i32 s65, 8192
v_and_b32_dpp v24, v21, v12 row_newbcast:0 row_mask:0xf bank_mask:0xf
v_and_b32_dpp v25, v21, v13 row_newbcast:0 row_mask:0xf bank_mask:0xf
v_and_b32_dpp v26, v21, v14 row_newbcast:0 row_mask:0xf bank_mask:0xf
v_and_b32_dpp v27, v21, v15 row_newbcast:0 row_mask:0xf bank_mask:0xf
s_nop 1
v_mfma_f32_16x16x32_bf16 v[28:31], v[24:27], v[84:87], v[28:31]
s_waitcnt vmcnt(4)
buffer_load_dwordx4 v[112:115], v4, s[32:35], s65 offen nt
s_addk_i32 s65, 8192
v_and_b32_dpp v24, v21, v12 row_newbcast:1 row_mask:0xf bank_mask:0xf
v_and_b32_dpp v25, v21, v13 row_newbcast:1 row_mask:0xf bank_mask:0xf
v_and_b32_dpp v26, v21, v14 row_newbcast:1 row_mask:0xf bank_mask:0xf
v_and_b32_dpp v27, v21, v15 row_newbcast:1 row_mask:0xf bank_mask:0xf
s_nop 1
v_mfma_f32_16x16x32_bf16 v[28:31], v[24:27], v[88:91], v[28:31]
s_waitcnt vmcnt(3)
buffer_load_dwordx4 v[120:123], v4, s[32:35], s65 offen nt
s_addk_i32 s65, 8192
v_and_b32_dpp v24, v21, v12 row_newbcast:2 row_mask:0xf bank_mask:0xf
v_and_b32_dpp v25, v21, v13 row_newbcast:2 row_mask:0xf bank_mask:0xf
v_and_b32_dpp v26, v21, v14 row_newbcast:2 row_mask:0xf bank_mask:0xf
v_and_b32_dpp v27, v21, v15 row_newbcast:2 row_mask:0xf bank_mask:0xf
s_nop 1
v_mfma_f32_16x16x32_bf16 v[28:31], v[24:27], v[96:99], v[28:31]
s_cmp_lt_u32 s61, 9
s_cbranch_scc1 L_roleO
s_cmp_lt_u32 s61, 27
s_cbranch_scc1 L_roleF
s_waitcnt vmcnt(3)
buffer_load_dwordx4 v[124:127], v4, s[32:35], s65 offen nt
s_addk_i32 s65, 8192
v_and_b32_dpp v24, v21, v12 row_newbcast:3 row_mask:0xf bank_mask:0xf
v_and_b32_dpp v25, v21, v13 row_newbcast:3 row_mask:0xf bank_mask:0xf
v_and_b32_dpp v26, v21, v14 row_newbcast:3 row_mask:0xf bank_mask:0xf
v_and_b32_dpp v27, v21, v15 row_newbcast:3 row_mask:0xf bank_mask:0xf
s_nop 1
v_mfma_f32_16x16x32_bf16 v[28:31], v[24:27], v[100:103], v[28:31]
s_waitcnt vmcnt(3)
buffer_load_dwordx4 v[132:135], v4, s[32:35], s65 offen nt
s_addk_i32 s65, 8192
v_and_b32_dpp v24, v21, v12 row_newbcast:4 row_mask:0xf bank_mask:0xf
v_and_b32_dpp v25, v21, v13 row_newbcast:4 row_mask:0xf bank_mask:0xf
v_and_b32_dpp v26, v21, v14 row_newbcast:4 row_mask:0xf bank_mask:0xf
v_and_b32_dpp v27, v21, v15 row_newbcast:4 row_mask:0xf bank_mask:0xf
s_nop 1
v_mfma_f32_16x16x32_bf16 v[28:31], v[24:27], v[108:111], v[28:31]
s_waitcnt vmcnt(3)
buffer_load_dwordx4 v[136:139], v4, s[32:35], s65 offen nt
s_addk_i32 s65, 8192
v_and_b32_dpp v24, v21, v12 row_newbcast:5 row_mask:0xf bank_mask:0xf
v_and_b32_dpp v25, v21, v13 row_newbcast:5 row_mask:0xf bank_mask:0xf
v_and_b32_dpp v26, v21, v14 row_newbcast:5 row_mask:0xf bank_mask:0xf
v_and_b32_dpp v27, v21, v15 row_newbcast:5 row_mask:0xf bank_mask:0xf
s_nop 1
v_mfma_f32_16x16x32_bf16 v[28:31], v[24:27], v[112:115], v[28:31]
s_waitcnt vmcnt(3)
buffer_load_dwordx4 v[144:147], v4, s[32:35], s65 offen nt
s_addk_i32 s65, 8192
v_and_b32_dpp v24, v21, v12 row_newbcast:6 row_mask:0xf bank_mask:0xf
v_and_b32_dpp v25, v21, v13 row_newbcast:6 row_mask:0xf bank_mask:0xf
v_and_b32_dpp v26, v21, v14 row_newbcast:6 row_mask:0xf bank_mask:0xf
v_and_b32_dpp v27, v21, v15 row_newbcast:6 row_mask:0xf bank_mask:0xf
s_nop 1
v_mfma_f32_16x16x32_bf16 v[28:31], v[24:27], v[120:123], v[28:31]
s_waitcnt vmcnt(3)
buffer_load_dwordx4 v[148:151], v4, s[32:35], s65 offen nt
s_addk_i32 s65, 8192
v_and_b32_dpp v24, v21, v12 row_newbcast:7 row_mask:0xf bank_mask:0xf
v_and_b32_dpp v25, v21, v13 row_newbcast:7 row_mask:0xf bank_mask:0xf
v_and_b32_dpp v26, v21, v14 row_newbcast:7 row_mask:0xf bank_mask:0xf
v_and_b32_dpp v27, v21, v15 row_newbcast:7 row_mask:0xf bank_mask:0xf
s_nop 1
v_mfma_f32_16x16x32_bf16 v[28:31], v[24:27], v[124:127], v[28:31]
s_waitcnt vmcnt(3)
buffer_load_dwordx4 v[156:159], v4, s[32:35], s65 offen nt
s_addk_i32 s65, 8192
v_and_b32_dpp v24, v21, v12 row_newbcast:8 row_mask:0xf bank_mask:0xf
v_and_b32_dpp v25, v21, v13 row_newbcast:8 row_mask:0xf bank_mask:0xf
v_and_b32_dpp v26, v21, v14 row_newbcast:8 row_mask:0xf bank_mask:0xf
v_and_b32_dpp v27, v21, v15 row_newbcast:8 row_mask:0xf bank_mask:0xf
s_nop 1
v_mfma_f32_16x16x32_bf16 v[28:31], v[24:27], v[132:135], v[28:31]
s_waitcnt vmcnt(3)
buffer_load_dwordx4 v[160:163], v4, s[32:35], s65 offen nt
s_addk_i32 s65, 8192
v_and_b32_dpp v24, v21, v12 row_newbcast:9 row_mask:0xf bank_mask:0xf
v_and_b32_dpp v25, v21, v13 row_newbcast:9 row_mask:0xf bank_mask:0xf
v_and_b32_dpp v26, v21, v14 row_newbcast:9 row_mask:0xf bank_mask:0xf
v_and_b32_dpp v27, v21, v15 row_newbcast:9 row_mask:0xf bank_mask:0xf
s_nop 1
v_mfma_f32_16x16x32_bf16 v[28:31], v[24:27], v[136:139], v[28:31]
s_waitcnt vmcnt(3)
buffer_load_dwordx4 v[168:171], v4, s[32:35], s65 offen nt
s_addk_i32 s65, 8192
v_and_b32_dpp v24, v21, v12 row_newbcast:10 row_mask:0xf bank_mask:0xf
v_and_b32_dpp v25, v21, v13 row_newbcast:10 row_mask:0xf bank_mask:0xf
v_and_b32_dpp v26, v21, v14 row_newbcast:10 row_mask:0xf bank_mask:0xf
v_and_b32_dpp v27, v21, v15 row_newbcast:10 row_mask:0xf bank_mask:0xf
s_nop 1
v_mfma_f32_16x16x32_bf16 v[28:31], v[24:27], v[144:147], v[28:31]
s_waitcnt vmcnt(3)
buffer_load_dwordx4 v[172:175], v4, s[32:35], s65 offen nt
v_and_b32_dpp v24, v21, v12 row_newbcast:11 row_mask:0xf bank_mask:0xf
v_and_b32_dpp v25, v21, v13 row_newbcast:11 row_mask:0xf bank_mask:0xf
v_and_b32_dpp v26, v21, v14 row_newbcast:11 row_mask:0xf bank_mask:0xf
v_and_b32_dpp v27, v21, v15 row_newbcast:11 row_mask:0xf bank_mask:0xf
s_nop 1
v_mfma_f32_16x16x32_bf16 v[28:31], v[24:27], v[148:151], v[28:31]
s_waitcnt vmcnt(3)
buffer_load_dword v250, v54, s[12:15], s101 offen
v_and_b32_dpp v24, v21, v12 row_newbcast:12 row_mask:0xf bank_mask:0xf
v_and_b32_dpp v25, v21, v13 row_newbcast:12 row_mask:0xf bank_mask:0xf
v_and_b32_dpp v26, v21, v14 row_newbcast:12 row_mask:0xf bank_mask:0xf
v_and_b32_dpp v27, v21, v15 row_newbcast:12 row_mask:0xf bank_mask:0xf
s_nop 1
v_mfma_f32_16x16x32_bf16 v[28:31], v[24:27], v[156:159], v[28:31]
s_waitcnt vmcnt(3)
buffer_load_dword v248, v55, s[48:51], s66 offen
v_and_b32_dpp v24, v21, v12 row_newbcast:13 row_mask:0xf bank_mask:0xf
v_and_b32_dpp v25, v21, v13 row_newbcast:13 row_mask:0xf bank_mask:0xf
v_and_b32_dpp v26, v21, v14 row_newbcast:13 row_mask:0xf bank_mask:0xf
v_and_b32_dpp v27, v21, v15 row_newbcast:13 row_mask:0xf bank_mask:0xf
s_nop 1
v_mfma_f32_16x16x32_bf16 v[28:31], v[24:27], v[160:163], v[28:31]
s_waitcnt vmcnt(3)
buffer_load_dword v249, v55, s[8:11], s66 offen
v_and_b32_dpp v24, v21, v12 row_newbcast:14 row_mask:0xf bank_mask:0xf
v_and_b32_dpp v25, v21, v13 row_newbcast:14 row_mask:0xf bank_mask:0xf
v_and_b32_dpp v26, v21, v14 row_newbcast:14 row_mask:0xf bank_mask:0xf
v_and_b32_dpp v27, v21, v15 row_newbcast:14 row_mask:0xf bank_mask:0xf
s_nop 1
v_mfma_f32_16x16x32_bf16 v[28:31], v[24:27], v[168:171], v[28:31]
v_and_b32_dpp v24, v21, v12 row_newbcast:15 row_mask:0xf bank_mask:0xf
v_and_b32_dpp v25, v21, v13 row_newbcast:15 row_mask:0xf bank_mask:0xf
v_and_b32_dpp v26, v21, v14 row_newbcast:15 row_mask:0xf bank_mask:0xf
v_and_b32_dpp v27, v21, v15 row_newbcast:15 row_mask:0xf bank_mask:0xf
s_waitcnt vmcnt(3)
s_nop 0
v_mfma_f32_16x16x32_bf16 v[28:31], v[24:27], v[172:175], v[28:31]
s_mov_b32 exec_hi, 0
s_nop 6
ds_write_b128 v38, v[28:31] offset:4608
s_mov_b32 exec_hi, -1
s_waitcnt lgkmcnt(0)
s_barrier
ds_read_b128 v[240:243], v32 offset:4608
s_cmp_eq_u32 s77, 1
s_waitcnt lgkmcnt(0)
v_add_f32_dpp v240, v240, v240 row_ror:8 row_mask:0xf bank_mask:0x3
v_add_f32_dpp v241, v241, v241 row_ror:8 row_mask:0xf bank_mask:0x3
v_add_f32_dpp v240, v242, v242 row_ror:8 row_mask:0xf bank_mask:0xc
v_add_f32_dpp v241, v243, v243 row_ror:8 row_mask:0xf bank_mask:0xc
s_nop 1
v_permlane16_swap_b32 v240, v241
v_add_f32 v240, v240, v241
v_mov_b32 v241, v240
s_nop 1
v_permlane32_swap_b32 v240, v241
v_add_f32 v240, v240, v241
v_min_u32 v240, -2, v240
s_cbranch_scc1 L_pl1
buffer_store_dword v240, v36, s[44:47], s78 offen sc1
s_branch L_pe1
L_pl1:
buffer_store_dword v240, v36, s[44:47], s78 offen
L_pe1:
s_endpgm
L_roleO:
v_and_b32 v6, 0x1f8, v0
v_lshlrev_b32 v49, 2, v6
s_lshl_b32 s68, s60, 9
v_add_u32 v6, s68, v6
v_mul_u32_u24 v6, 1152, v6
v_and_b32 v7, 7, v1
v_lshl_add_u32 v40, v7, 4, v6
s_lshl_b32 s64, s61, 7
s_waitcnt vmcnt(3)
buffer_load_dwordx4 v[124:127], v4, s[32:35], s65 offen nt
s_addk_i32 s65, 8192
v_and_b32_dpp v24, v21, v12 row_newbcast:3 row_mask:0xf bank_mask:0xf
v_and_b32_dpp v25, v21, v13 row_newbcast:3 row_mask:0xf bank_mask:0xf
v_and_b32_dpp v26, v21, v14 row_newbcast:3 row_mask:0xf bank_mask:0xf
v_and_b32_dpp v27, v21, v15 row_newbcast:3 row_mask:0xf bank_mask:0xf
s_nop 1
v_mfma_f32_16x16x32_bf16 v[28:31], v[24:27], v[100:103], v[28:31]
s_lshr_b32 s68, s3, 1
s_lshl2_add_u32 s68, s60, s68
s_lshl_b32 s69, s68, 12
s_and_b32 s70, s69, 0xffffe000
s_add_u32 s69, s69, s70
s_add_u32 s69, s69, s78
v_and_b32 v6, 127, v0
v_lshl_add_u32 v41, v6, 2, s69
s_lshl_b32 s69, s68, 7
s_add_u32 s69, s69, 262144
s_add_u32 s69, s69, s78
v_and_b32 v6, 7, v1
v_lshl_add_u32 v42, v6, 4, s69
v_bfe_u32 v7, v1, 3, 1
v_lshl_add_u32 v42, v7, 2, v42
v_lshlrev_b32 v48, 2, v0
v_lshrrev_b32 v7, 3, v3
v_lshrrev_b32 v8, 1, v2
v_cmp_eq_u32 s[72:73], v7, v8
v_lshrrev_b32 v7, 3, v1
v_lshlrev_b32 v7, 8, v7
v_lshl_add_u32 v7, v6, 4, v7
s_and_b32 s68, s3, 1
s_lshl_b32 s68, s68, 7
v_add_u32 v51, s68, v7
s_mul_i32 s69, s60, 43
s_lshr_b32 s69, s69, 7
s_mul_i32 s69, s69, 9472
s_add_u32 s68, s68, s69
s_lshl_b32 s69, s67, 8
s_waitcnt vmcnt(3)
buffer_load_dwordx4 v[132:135], v4, s[32:35], s65 offen nt
s_addk_i32 s65, 8192
v_and_b32_dpp v24, v21, v12 row_newbcast:4 row_mask:0xf bank_mask:0xf
v_and_b32_dpp v25, v21, v13 row_newbcast:4 row_mask:0xf bank_mask:0xf
v_and_b32_dpp v26, v21, v14 row_newbcast:4 row_mask:0xf bank_mask:0xf
v_and_b32_dpp v27, v21, v15 row_newbcast:4 row_mask:0xf bank_mask:0xf
s_nop 1
v_mfma_f32_16x16x32_bf16 v[28:31], v[24:27], v[108:111], v[28:31]
s_add_u32 s68, s68, s69
s_add_u32 s68, s68, 278528
v_add_u32 v7, s68, v35
v_and_b32 v8, 0x1a0, v0
v_cmp_eq_u32 vcc, 0, v8
s_movk_i32 s4, 0x2000
s_nop 0
v_cndmask_b32 v46, v22, v7, vcc
v_and_b32 v6, 1, v1
v_bfe_u32 v7, v1, 3, 1
v_bfe_u32 v8, v1, 2, 1
v_lshl_add_u32 v7, v7, 1, v8
v_lshl_add_u32 v6, v6, 2, v7
s_and_b32 s68, s60, 3
s_mul_i32 s68, s68, 9
s_add_u32 s5, s68, s61
s_lshr_b32 s68, s78, 10
s_lshl4_add_u32 s68, s5, s68
v_add_u32 v6, s68, v6
v_lshlrev_b32 v45, 1, v6
buffer_load_ushort v35, v45, s[40:43], 0 offen
v_bfe_u32 v7, v1, 1, 1
v_lshl_add_u32 v7, v2, 1, v7
v_mul_u32_u24 v8, 43, v7
v_lshrrev_b32 v8, 7, v8
v_mul_u32_u24 v8, 9472, v8
v_mul_u32_u24 v7, 2304, v7
v_add_u32 v8, v8, v7
s_add_u32 s69, s78, 278528
v_lshl_add_u32 v8, v6, 2, v8
v_add_u32 v43, s69, v8
s_waitcnt vmcnt(4)
buffer_load_dwordx4 v[136:139], v4, s[32:35], s65 offen nt
s_addk_i32 s65, 8192
v_and_b32_dpp v24, v21, v12 row_newbcast:5 row_mask:0xf bank_mask:0xf
v_and_b32_dpp v25, v21, v13 row_newbcast:5 row_mask:0xf bank_mask:0xf
v_and_b32_dpp v26, v21, v14 row_newbcast:5 row_mask:0xf bank_mask:0xf
v_and_b32_dpp v27, v21, v15 row_newbcast:5 row_mask:0xf bank_mask:0xf
s_nop 1
v_mfma_f32_16x16x32_bf16 v[28:31], v[24:27], v[112:115], v[28:31]
s_mul_i32 s68, s5, 4608
s_add_u32 s68, s68, 163840
v_lshl_add_u32 v6, v1, 4, s68
v_and_b32 v7, 0xffffe000, v6
v_add3_u32 v56, v6, v7, s78
v_add_u32 v6, 0x400, v6
v_and_b32 v7, 0xffffe000, v6
v_add3_u32 v57, v6, v7, s78
v_add_u32 v6, 0x400, v6
v_and_b32 v7, 0xffffe000, v6
v_add3_u32 v58, v6, v7, s78
v_add_u32 v6, 0x400, v6
v_and_b32 v7, 0xffffe000, v6
v_add3_u32 v59, v6, v7, s78
v_add_u32 v6, 0x400, v6
v_and_b32 v7, 0xffffe000, v6
v_add3_u32 v60, v6, v7, s78
v_cmp_gt_u32 vcc, 32, v1
v_and_b32 v6, 0x32, v1
s_nop 0
v_cndmask_b32 v60, v22, v60, vcc
v_cmp_eq_u32 vcc, 0, v6
s_mov_b32 s69, 0x3fb8aa3b
s_nop 0
v_cndmask_b32 v45, v22, v45, vcc
s_waitcnt vmcnt(4)
buffer_load_dwordx4 v[144:147], v4, s[32:35], s65 offen nt
s_addk_i32 s65, 8192
v_and_b32_dpp v24, v21, v12 row_newbcast:6 row_mask:0xf bank_mask:0xf
v_and_b32_dpp v25, v21, v13 row_newbcast:6 row_mask:0xf bank_mask:0xf
v_and_b32_dpp v26, v21, v14 row_newbcast:6 row_mask:0xf bank_mask:0xf
v_and_b32_dpp v27, v21, v15 row_newbcast:6 row_mask:0xf bank_mask:0xf
s_nop 1
v_mfma_f32_16x16x32_bf16 v[28:31], v[24:27], v[120:123], v[28:31]
s_waitcnt vmcnt(4)
buffer_load_dwordx4 v[148:151], v4, s[32:35], s65 offen nt
s_addk_i32 s65, 8192
v_and_b32_dpp v24, v21, v12 row_newbcast:7 row_mask:0xf bank_mask:0xf
v_and_b32_dpp v25, v21, v13 row_newbcast:7 row_mask:0xf bank_mask:0xf
v_and_b32_dpp v26, v21, v14 row_newbcast:7 row_mask:0xf bank_mask:0xf
v_and_b32_dpp v27, v21, v15 row_newbcast:7 row_mask:0xf bank_mask:0xf
s_nop 1
v_mfma_f32_16x16x32_bf16 v[28:31], v[24:27], v[124:127], v[28:31]
s_waitcnt vmcnt(4)
buffer_load_dwordx4 v[156:159], v4, s[32:35], s65 offen nt
s_addk_i32 s65, 8192
v_and_b32_dpp v24, v21, v12 row_newbcast:8 row_mask:0xf bank_mask:0xf
v_and_b32_dpp v25, v21, v13 row_newbcast:8 row_mask:0xf bank_mask:0xf
v_and_b32_dpp v26, v21, v14 row_newbcast:8 row_mask:0xf bank_mask:0xf
v_and_b32_dpp v27, v21, v15 row_newbcast:8 row_mask:0xf bank_mask:0xf
s_nop 1
v_mfma_f32_16x16x32_bf16 v[28:31], v[24:27], v[132:135], v[28:31]
s_waitcnt vmcnt(3)
buffer_load_dwordx4 v[160:163], v4, s[32:35], s65 offen nt
s_addk_i32 s65, 8192
v_and_b32_dpp v24, v21, v12 row_newbcast:9 row_mask:0xf bank_mask:0xf
v_and_b32_dpp v25, v21, v13 row_newbcast:9 row_mask:0xf bank_mask:0xf
v_and_b32_dpp v26, v21, v14 row_newbcast:9 row_mask:0xf bank_mask:0xf
v_and_b32_dpp v27, v21, v15 row_newbcast:9 row_mask:0xf bank_mask:0xf
s_nop 1
v_mfma_f32_16x16x32_bf16 v[28:31], v[24:27], v[136:139], v[28:31]
s_waitcnt vmcnt(3)
buffer_load_dwordx4 v[168:171], v4, s[32:35], s65 offen nt
s_addk_i32 s65, 8192
v_and_b32_dpp v24, v21, v12 row_newbcast:10 row_mask:0xf bank_mask:0xf
v_and_b32_dpp v25, v21, v13 row_newbcast:10 row_mask:0xf bank_mask:0xf
v_and_b32_dpp v26, v21, v14 row_newbcast:10 row_mask:0xf bank_mask:0xf
v_and_b32_dpp v27, v21, v15 row_newbcast:10 row_mask:0xf bank_mask:0xf
s_nop 1
v_mfma_f32_16x16x32_bf16 v[28:31], v[24:27], v[144:147], v[28:31]
s_waitcnt vmcnt(3)
buffer_load_dwordx4 v[172:175], v4, s[32:35], s65 offen nt
v_and_b32_dpp v24, v21, v12 row_newbcast:11 row_mask:0xf bank_mask:0xf
v_and_b32_dpp v25, v21, v13 row_newbcast:11 row_mask:0xf bank_mask:0xf
v_and_b32_dpp v26, v21, v14 row_newbcast:11 row_mask:0xf bank_mask:0xf
v_and_b32_dpp v27, v21, v15 row_newbcast:11 row_mask:0xf bank_mask:0xf
s_nop 1
v_mfma_f32_16x16x32_bf16 v[28:31], v[24:27], v[148:151], v[28:31]
s_waitcnt vmcnt(3)
buffer_load_dword v250, v54, s[12:15], s101 offen
v_and_b32_dpp v24, v21, v12 row_newbcast:12 row_mask:0xf bank_mask:0xf
v_and_b32_dpp v25, v21, v13 row_newbcast:12 row_mask:0xf bank_mask:0xf
v_and_b32_dpp v26, v21, v14 row_newbcast:12 row_mask:0xf bank_mask:0xf
v_and_b32_dpp v27, v21, v15 row_newbcast:12 row_mask:0xf bank_mask:0xf
s_nop 1
v_mfma_f32_16x16x32_bf16 v[28:31], v[24:27], v[156:159], v[28:31]
s_waitcnt vmcnt(3)
buffer_load_dword v248, v55, s[48:51], s66 offen
v_and_b32_dpp v24, v21, v12 row_newbcast:13 row_mask:0xf bank_mask:0xf
v_and_b32_dpp v25, v21, v13 row_newbcast:13 row_mask:0xf bank_mask:0xf
v_and_b32_dpp v26, v21, v14 row_newbcast:13 row_mask:0xf bank_mask:0xf
v_and_b32_dpp v27, v21, v15 row_newbcast:13 row_mask:0xf bank_mask:0xf
s_nop 1
v_mfma_f32_16x16x32_bf16 v[28:31], v[24:27], v[160:163], v[28:31]
s_waitcnt vmcnt(3)
buffer_load_dword v249, v55, s[8:11], s66 offen
v_and_b32_dpp v24, v21, v12 row_newbcast:14 row_mask:0xf bank_mask:0xf
v_and_b32_dpp v25, v21, v13 row_newbcast:14 row_mask:0xf bank_mask:0xf
v_and_b32_dpp v26, v21, v14 row_newbcast:14 row_mask:0xf bank_mask:0xf
v_and_b32_dpp v27, v21, v15 row_newbcast:14 row_mask:0xf bank_mask:0xf
s_nop 1
v_mfma_f32_16x16x32_bf16 v[28:31], v[24:27], v[168:171], v[28:31]
s_waitcnt vmcnt(3)
buffer_load_dwordx4 v[180:183], v40, s[12:15], s64 offen
s_addk_i32 s64, 1152
v_and_b32_dpp v24, v21, v12 row_newbcast:15 row_mask:0xf bank_mask:0xf
v_and_b32_dpp v25, v21, v13 row_newbcast:15 row_mask:0xf bank_mask:0xf
v_and_b32_dpp v26, v21, v14 row_newbcast:15 row_mask:0xf bank_mask:0xf
v_and_b32_dpp v27, v21, v15 row_newbcast:15 row_mask:0xf bank_mask:0xf
s_nop 1
v_mfma_f32_16x16x32_bf16 v[28:31], v[24:27], v[172:175], v[28:31]
s_mov_b32 exec_hi, 0
s_nop 6
ds_write_b128 v38, v[28:31] offset:4608
s_mov_b32 exec_hi, -1
s_waitcnt lgkmcnt(0)
s_barrier
ds_read_b128 v[240:243], v32 offset:4608
s_cmp_eq_u32 s77, 1
s_waitcnt lgkmcnt(0)
v_add_f32_dpp v240, v240, v240 row_ror:8 row_mask:0xf bank_mask:0x3
v_add_f32_dpp v241, v241, v241 row_ror:8 row_mask:0xf bank_mask:0x3
v_add_f32_dpp v240, v242, v242 row_ror:8 row_mask:0xf bank_mask:0xc
v_add_f32_dpp v241, v243, v243 row_ror:8 row_mask:0xf bank_mask:0xc
s_nop 1
v_permlane16_swap_b32 v240, v241
v_add_f32 v240, v240, v241
v_mov_b32 v241, v240
s_nop 1
v_permlane32_swap_b32 v240, v241
v_add_f32 v240, v240, v241
v_min_u32 v240, -2, v240
s_cbranch_scc1 L_pl2
buffer_store_dword v240, v36, s[44:47], s78 offen sc1
s_branch L_pe2
L_pl2:
buffer_store_dword v240, v36, s[44:47], s78 offen
L_pe2:
buffer_load_dwordx4 v[184:187], v40, s[12:15], s64 offen
s_addk_i32 s64, 1152
buffer_load_dwordx4 v[192:195], v40, s[12:15], s64 offen
s_addk_i32 s64, 1152
buffer_load_dwordx4 v[196:199], v40, s[12:15], s64 offen
s_addk_i32 s64, 1152
buffer_load_dwordx4 v[204:207], v40, s[12:15], s64 offen
s_addk_i32 s64, 1152
buffer_load_dwordx4 v[208:211], v40, s[12:15], s64 offen
s_addk_i32 s64, 1152
buffer_load_dwordx4 v[216:219], v40, s[12:15], s64 offen
s_addk_i32 s64, 1152
buffer_load_dwordx4 v[220:223], v40, s[12:15], s64 offen
s_addk_i32 s64, 1152
L_mlp:
buffer_load_dword v80, v42, s[44:47], 0 offen sc1
buffer_load_dword v228, v41, s[44:47], 0 offen offset:0 sc1
buffer_load_dword v229, v41, s[44:47], 0 offen offset:512 sc1
buffer_load_dword v230, v41, s[44:47], 0 offen offset:1024 sc1
buffer_load_dword v231, v41, s[44:47], 0 offen offset:1536 sc1
buffer_load_dword v232, v41, s[44:47], 0 offen offset:2048 sc1
buffer_load_dword v233, v41, s[44:47], 0 offen offset:2560 sc1
buffer_load_dword v234, v41, s[44:47], 0 offen offset:3072 sc1
buffer_load_dword v235, v41, s[44:47], 0 offen offset:3584 sc1
s_waitcnt vmcnt(8)
v_cmp_eq_u32 vcc, -1, v80
s_cbranch_vccz L_mlok
s_waitcnt vmcnt(0)
s_sub_u32 s71, s71, 1
s_cbranch_scc0 L_mlp
s_mov_b32 s71, 0
L_mlok:
v_mov_b32_dpp v81, v80 row_ror:8 row_mask:0xf bank_mask:0xf
v_max_f32_dpp v10, v80, v80 quad_perm:[1,0,3,2] row_mask:0xf bank_mask:0xf
s_nop 1
v_max_f32_dpp v10, v10, v10 quad_perm:[2,3,0,1] row_mask:0xf bank_mask:0xf
s_nop 1
v_max_f32_dpp v10, v10, v10 row_half_mirror row_mask:0xf bank_mask:0xf
v_sub_f32 v10, v80, v10
v_mul_f32 v10, s69, v10
v_exp_f32 v10, v10
s_nop 0
v_mul_f32 v7, v10, v81
s_nop 1
v_add_f32_dpp v7, v7, v7 quad_perm:[1,0,3,2] row_mask:0xf bank_mask:0xf
s_nop 1
v_add_f32_dpp v7, v7, v7 quad_perm:[2,3,0,1] row_mask:0xf bank_mask:0xf
s_nop 1
v_add_f32_dpp v7, v7, v7 row_half_mirror row_mask:0xf bank_mask:0xf
v_rcp_f32 v7, v7
s_nop 0
v_mul_f32 v10, v10, v7
L_pollO1:
s_waitcnt vmcnt(0)
v_max_u32 v6, v228, v229
v_max3_u32 v6, v6, v230, v231
v_max3_u32 v6, v6, v232, v233
v_max3_u32 v6, v6, v234, v235
v_cmp_eq_u32 vcc, -1, v6
s_cbranch_vccz L_pollokO1
v_cmp_eq_u32 vcc, -1, v228
s_cbranch_vccz L_skO1_0
buffer_load_dword v228, v41, s[44:47], 0 offen offset:0 sc1
L_skO1_0:
v_cmp_eq_u32 vcc, -1, v229
s_cbranch_vccz L_skO1_1
buffer_load_dword v229, v41, s[44:47], 0 offen offset:512 sc1
L_skO1_1:
v_cmp_eq_u32 vcc, -1, v230
s_cbranch_vccz L_skO1_2
buffer_load_dword v230, v41, s[44:47], 0 offen offset:1024 sc1
L_skO1_2:
v_cmp_eq_u32 vcc, -1, v231
s_cbranch_vccz L_skO1_3
buffer_load_dword v231, v41, s[44:47], 0 offen offset:1536 sc1
L_skO1_3:
v_cmp_eq_u32 vcc, -1, v232
s_cbranch_vccz L_skO1_4
buffer_load_dword v232, v41, s[44:47], 0 offen offset:2048 sc1
L_skO1_4:
v_cmp_eq_u32 vcc, -1, v233
s_cbranch_vccz L_skO1_5
buffer_load_dword v233, v41, s[44:47], 0 offen offset:2560 sc1
L_skO1_5:
v_cmp_eq_u32 vcc, -1, v234
s_cbranch_vccz L_skO1_6
buffer_load_dword v234, v41, s[44:47], 0 offen offset:3072 sc1
L_skO1_6:
v_cmp_eq_u32 vcc, -1, v235
s_cbranch_vccz L_skO1_7
buffer_load_dword v235, v41, s[44:47], 0 offen offset:3584 sc1
L_skO1_7:
s_sub_u32 s71, s71, 1
s_cbranch_scc0 L_pollO1
s_mov_b32 s71, 0
s_waitcnt vmcnt(0)
L_pollokO1:
v_mul_f32_dpp v7, v10, v228 row_newbcast:0 row_mask:0xf bank_mask:0xf
v_fmac_f32_dpp v7, v10, v229 row_newbcast:1 row_mask:0xf bank_mask:0xf
v_fmac_f32_dpp v7, v10, v230 row_newbcast:2 row_mask:0xf bank_mask:0xf
v_fmac_f32_dpp v7, v10, v231 row_newbcast:3 row_mask:0xf bank_mask:0xf
v_fmac_f32_dpp v7, v10, v232 row_newbcast:4 row_mask:0xf bank_mask:0xf
v_fmac_f32_dpp v7, v10, v233 row_newbcast:5 row_mask:0xf bank_mask:0xf
v_fmac_f32_dpp v7, v10, v234 row_newbcast:6 row_mask:0xf bank_mask:0xf
v_fmac_f32_dpp v7, v10, v235 row_newbcast:7 row_mask:0xf bank_mask:0xf
v_cvt_pk_bf16_f32 v7, v7, v7
ds_write_b32 v48, v7 offset:8704
ds_read_b128 v[228:231], v49 offset:8704
ds_read_b128 v[232:235], v49 offset:8720
s_waitcnt lgkmcnt(0)
v_and_b32 v24, v228, v12
v_and_b32 v25, v228, v13
v_and_b32 v26, v228, v14
v_and_b32 v27, v228, v15
v_and_b32 v240, v229, v12
v_and_b32 v241, v229, v13
v_and_b32 v242, v229, v14
v_and_b32 v243, v229, v15
v_mfma_f32_16x16x32_bf16 v[28:31], v[24:27], v[180:183], 0
v_and_b32 v24, v230, v12
v_and_b32 v25, v230, v13
v_and_b32 v26, v230, v14
v_and_b32 v27, v230, v15
v_mfma_f32_16x16x32_bf16 v[28:31], v[240:243], v[184:187], v[28:31]
v_and_b32 v240, v231, v12
v_and_b32 v241, v231, v13
v_and_b32 v242, v231, v14
v_and_b32 v243, v231, v15
v_mfma_f32_16x16x32_bf16 v[28:31], v[24:27], v[192:195], v[28:31]
v_and_b32 v24, v232, v12
v_and_b32 v25, v232, v13
v_and_b32 v26, v232, v14
v_and_b32 v27, v232, v15
v_mfma_f32_16x16x32_bf16 v[28:31], v[240:243], v[196:199], v[28:31]
v_and_b32 v240, v233, v12
v_and_b32 v241, v233, v13
v_and_b32 v242, v233, v14
v_and_b32 v243, v233, v15
v_mfma_f32_16x16x32_bf16 v[28:31], v[24:27], v[204:207], v[28:31]
v_and_b32 v24, v234, v12
v_and_b32 v25, v234, v13
v_and_b32 v26, v234, v14
v_and_b32 v27, v234, v15
v_mfma_f32_16x16x32_bf16 v[28:31], v[240:243], v[208:211], v[28:31]
v_and_b32 v240, v235, v12
v_and_b32 v241, v235, v13
v_and_b32 v242, v235, v14
v_and_b32 v243, v235, v15
v_mfma_f32_16x16x32_bf16 v[28:31], v[24:27], v[216:219], v[28:31]
s_nop 0
v_mfma_f32_16x16x32_bf16 v[28:31], v[240:243], v[220:223], v[28:31]
s_mov_b64 exec, s[72:73]
s_nop 6
ds_write_b128 v38, v[28:31] offset:10752
s_mov_b64 exec, -1
s_cmp_gt_u32 s3, 2
s_waitcnt lgkmcnt(0)
s_barrier
s_cbranch_scc1 L_Oend
s_cmp_eq_u32 s3, 2
s_cbranch_scc1 L_R
ds_read_b128 v[240:243], v51 offset:10752
ds_read_b128 v[244:247], v51 offset:12800
s_waitcnt lgkmcnt(0)
v_add_f32 v240, v240, v244
v_add_f32 v241, v241, v245
v_add_f32 v242, v242, v246
v_add_f32 v243, v243, v247
v_add_f32_dpp v240, v240, v240 row_ror:8 row_mask:0xf bank_mask:0x3
v_add_f32_dpp v241, v241, v241 row_ror:8 row_mask:0xf bank_mask:0x3
v_add_f32_dpp v240, v242, v242 row_ror:8 row_mask:0xf bank_mask:0xc
v_add_f32_dpp v241, v243, v243 row_ror:8 row_mask:0xf bank_mask:0xc
s_nop 1
v_permlane16_swap_b32 v240, v241
v_add_f32 v240, v240, v241
v_mov_b32 v241, v240
s_nop 1
v_permlane32_swap_b32 v240, v241
v_add_f32 v240, v240, v241
v_min_u32 v240, -2, v240
buffer_store_dword v240, v46, s[44:47], 0 offen sc1
buffer_store_dword v240, v46, s[44:47], s4 offen sc1
s_branch L_Oend
L_R:
L_pollO2:
buffer_load_dword v80, v43, s[44:47], 0 offen sc1
s_waitcnt vmcnt(0)
v_cmp_eq_u32 vcc, -1, v80
s_cbranch_vccz L_pollokO2
s_sub_u32 s71, s71, 1
s_cbranch_scc0 L_pollO2
s_mov_b32 s71, 0
L_pollokO2:
v_add_f32_dpp v80, v80, v80 quad_perm:[2,3,0,1] row_mask:0xf bank_mask:0xf
v_mov_b32 v7, v80
s_nop 1
v_permlane16_swap_b32 v80, v7
v_add_f32 v80, v80, v7
v_mov_b32 v7, v80
s_nop 1
v_permlane32_swap_b32 v80, v7
v_add_f32 v80, v80, v7
v_cvt_pk_bf16_f32 v80, v80, v80
v_and_b32 v80, 0xffff0000, v80
v_lshlrev_b32 v35, 16, v35
v_add_f32 v80, v80, v35
v_cvt_pk_bf16_f32 v80, v80, v80
v_and_b32 v80, 0xffff0000, v80
L_gate3:
buffer_load_dword v152, v56, s[44:47], 0 offen sc1
s_waitcnt vmcnt(0)
v_cmp_eq_u32 vcc, -1, v152
s_nop 0
s_bcnt1_i32_b64 s68, vcc
s_cmp_le_u32 s68, 48
s_cbranch_scc1 L_gateok3
s_sub_u32 s71, s71, 1
s_cbranch_scc0 L_gate3
s_mov_b32 s71, 0
L_gateok3:
L_pollO3:
buffer_load_dwordx4 v[164:167], v56, s[44:47], 0 offen sc1
buffer_load_dwordx4 v[176:179], v57, s[44:47], 0 offen sc1
buffer_load_dwordx4 v[188:191], v58, s[44:47], 0 offen sc1
buffer_load_dwordx4 v[200:203], v59, s[44:47], 0 offen sc1
buffer_load_dwordx4 v[212:215], v60, s[44:47], 0 offen sc1
s_waitcnt vmcnt(0)
v_max_u32 v6, v164, v165
v_max3_u32 v6, v6, v166, v167
v_max3_u32 v6, v6, v176, v177
v_max3_u32 v6, v6, v178, v179
v_max3_u32 v6, v6, v188, v189
v_max3_u32 v6, v6, v190, v191
v_max3_u32 v6, v6, v200, v201
v_max3_u32 v6, v6, v202, v203
v_max3_u32 v6, v6, v212, v213
v_max3_u32 v6, v6, v214, v215
v_cmp_eq_u32 vcc, -1, v6
s_cbranch_vccz L_pollokO3
s_sub_u32 s71, s71, 1
s_cbranch_scc0 L_pollO3
s_mov_b32 s71, 0
L_pollokO3:
v_add_f32 v92, v164, v176
v_add_f32 v152, v188, v200
v_add_f32 v93, v165, v177
v_add_f32 v153, v189, v201
v_add_f32 v94, v166, v178
v_add_f32 v154, v190, v202
v_add_f32 v95, v167, v179
v_add_f32 v155, v191, v203
v_add_f32 v92, v92, v212
v_add_f32 v93, v93, v213
v_add_f32 v94, v94, v214
v_add_f32 v95, v95, v215
v_add_f32 v92, v92, v152
v_add_f32 v93, v93, v153
v_add_f32 v94, v94, v154
v_add_f32 v95, v95, v155
v_add_f32_dpp v92, v92, v92 row_ror:8 row_mask:0xf bank_mask:0x3
v_add_f32_dpp v93, v93, v93 row_ror:8 row_mask:0xf bank_mask:0x3
v_add_f32_dpp v92, v94, v94 row_ror:8 row_mask:0xf bank_mask:0xc
v_add_f32_dpp v93, v95, v95 row_ror:8 row_mask:0xf bank_mask:0xc
s_nop 0
v_add_f32_dpp v92, v92, v92 row_shl:4 row_mask:0xf bank_mask:0x5
v_add_f32_dpp v92, v93, v93 row_shr:4 row_mask:0xf bank_mask:0xa
s_nop 1
v_add_f32_dpp v92, v92, v92 quad_perm:[2,3,0,1] row_mask:0xf bank_mask:0xf
v_mov_b32 v7, v92
s_nop 1
v_permlane16_swap_b32 v92, v7
v_add_f32 v92, v92, v7
v_mov_b32 v7, v92
s_nop 1
v_permlane32_swap_b32 v92, v7
v_add_f32 v92, v92, v7
v_cvt_pk_bf16_f32 v92, v92, v92
v_and_b32 v92, 0xffff0000, v92
v_add_f32 v92, v92, v80
v_cvt_pk_bf16_f32 v92, v92, v92
buffer_store_short v92, v45, s[24:27], 0 offen
L_Oend:
s_endpgm
L_roleF:
s_waitcnt vmcnt(3)
buffer_load_dwordx4 v[136:139], v4, s[32:35], s65 offen nt
s_addk_i32 s65, 8192
v_and_b32_dpp v24, v21, v12 row_newbcast:3 row_mask:0xf bank_mask:0xf
v_and_b32_dpp v25, v21, v13 row_newbcast:3 row_mask:0xf bank_mask:0xf
v_and_b32_dpp v26, v21, v14 row_newbcast:3 row_mask:0xf bank_mask:0xf
v_and_b32_dpp v27, v21, v15 row_newbcast:3 row_mask:0xf bank_mask:0xf
s_nop 1
v_mfma_f32_16x16x32_bf16 v[28:31], v[24:27], v[100:103], v[28:31]
s_mul_i32 s69, s3, 144
v_and_b32 v8, 7, v1
s_lshl_b32 s19, s67, 5
s_add_u32 s19, s19, 163840
s_mul_i32 s68, s3, 9
v_lshrrev_b32 v7, 3, v1
v_cmp_gt_u32 s[74:75], 8, v1
v_add3_u32 v9, v7, s68, 0
v_and_b32 v11, 1, v9
v_lshrrev_b32 v9, 1, v9
v_mul_u32_u24 v9, 4608, v9
v_lshl_add_u32 v9, v8, 2, v9
v_add_u32 v43, s19, v9
v_and_b32 v10, 0xffffe000, v43
v_lshl_add_u32 v10, v11, 13, v10
v_add_u32 v43, v43, v10
v_add3_u32 v9, v7, s68, 8
v_and_b32 v11, 1, v9
v_lshrrev_b32 v9, 1, v9
v_mul_u32_u24 v9, 4608, v9
v_lshl_add_u32 v9, v8, 2, v9
v_add_u32 v61, s19, v9
v_and_b32 v10, 0xffffe000, v61
v_lshl_add_u32 v10, v11, 13, v10
v_add_u32 v61, v61, v10
v_cndmask_b32 v61, v22, v61, s[74:75]
v_lshl_add_u32 v9, v1, 1, s69
buffer_load_ushort v51, v9, s[40:43], 0 offen
v_lshl_add_u32 v9, v8, 1, s69
buffer_load_ushort v52, v9, s[40:43], 0 offen offset:128
s_waitcnt vmcnt(5)
buffer_load_dwordx4 v[144:147], v4, s[32:35], s65 offen nt
s_addk_i32 s65, 8192
v_and_b32_dpp v24, v21, v12 row_newbcast:4 row_mask:0xf bank_mask:0xf
v_and_b32_dpp v25, v21, v13 row_newbcast:4 row_mask:0xf bank_mask:0xf
v_and_b32_dpp v26, v21, v14 row_newbcast:4 row_mask:0xf bank_mask:0xf
v_and_b32_dpp v27, v21, v15 row_newbcast:4 row_mask:0xf bank_mask:0xf
s_nop 1
v_mfma_f32_16x16x32_bf16 v[28:31], v[24:27], v[108:111], v[28:31]
s_add_u32 s19, s78, 278528
s_lshl1_add_u32 s70, s69, s19
v_lshl_add_u32 v42, v1, 2, s70
v_mul_u32_u24 v9, 43, v7
v_lshrrev_b32 v9, 7, v9
v_mul_u32_u24 v9, 9472, v9
v_mul_u32_u24 v7, 2304, v7
v_add_u32 v9, v9, v7
v_lshl_add_u32 v7, v8, 2, v9
v_add_u32 v53, s70, v7
s_sub_u32 s68, s61, 9
s_lshl_b32 s68, s68, 7
s_add_u32 s68, s68, s19
v_cmp_gt_u32 vcc, 64, v0
v_add_u32 v7, s68, v7
s_mul_i32 s68, s3, 384
v_cndmask_b32 v60, v22, v7, vcc
s_add_u32 s68, s68, 9216
v_mov_b32 v9, 8832
v_mul_u32_u24 v7, 57, v1
v_lshrrev_b32 v7, 9, v7
v_mad_u32_u24 v7, v7, 3, v1
v_lshl_add_u32 v44, v7, 2, s68
s_add_u32 s68, s68, 340
v_lshl_add_u32 v45, v8, 2, s68
v_cmp_eq_u32 vcc, 63, v1
v_lshlrev_b32 v7, 1, v39
v_add_u32 v7, 8704, v7
v_cndmask_b32 v47, v9, v7, vcc
s_lshl_b32 s70, s3, 10
s_waitcnt vmcnt(5)
buffer_load_dwordx4 v[148:151], v4, s[32:35], s65 offen nt
s_addk_i32 s65, 8192
v_and_b32_dpp v24, v21, v12 row_newbcast:5 row_mask:0xf bank_mask:0xf
v_and_b32_dpp v25, v21, v13 row_newbcast:5 row_mask:0xf bank_mask:0xf
v_and_b32_dpp v26, v21, v14 row_newbcast:5 row_mask:0xf bank_mask:0xf
v_and_b32_dpp v27, v21, v15 row_newbcast:5 row_mask:0xf bank_mask:0xf
s_nop 1
v_mfma_f32_16x16x32_bf16 v[28:31], v[24:27], v[112:115], v[28:31]
s_add_u32 s70, s70, 21504
s_mov_b32 s16, 4608
s_mov_b32 s17, 16384
s_mov_b32 s18, 20992
s_mov_b32 s20, 32768
v_lshrrev_b32 v6, 3, v0
v_mul_u32_u24 v48, 48, v6
v_mul_u32_u24 v6, 82944, v6
v_and_b32 v7, 3, v1
v_lshl_add_u32 v40, v7, 4, v6
s_lshl_b32 s68, s67, 6
s_mov_b32 s4, 0xf0f0f0f0
s_mov_b32 s5, 0xf0f0f0f0
v_add_u32 v40, s68, v40
v_mov_b32 v6, s48
v_mov_b32 v7, s8
v_mov_b32 v8, s49
v_mov_b32 v9, s9
v_cndmask_b32 v6, v6, v7, s[4:5]
v_cndmask_b32 v8, v8, v9, s[4:5]
v_add_co_u32 v56, vcc, v6, v40
s_nop 1
v_addc_co_u32 v57, vcc, 0, v8, vcc
v_lshrrev_b32 v7, 3, v3
v_lshrrev_b32 v8, 1, v2
v_cmp_eq_u32 s[72:73], v7, v8
v_bfe_u32 v8, v1, 2, 1
v_lshl_add_u32 v8, v8, 4, v7
v_mul_u32_u24 v8, 144, v8
v_and_b32 v9, 0x70, v38
s_mul_i32 s68, s3, 288
s_waitcnt vmcnt(5)
buffer_load_dwordx4 v[156:159], v4, s[32:35], s65 offen nt
s_addk_i32 s65, 8192
v_and_b32_dpp v24, v21, v12 row_newbcast:6 row_mask:0xf bank_mask:0xf
v_and_b32_dpp v25, v21, v13 row_newbcast:6 row_mask:0xf bank_mask:0xf
v_and_b32_dpp v26, v21, v14 row_newbcast:6 row_mask:0xf bank_mask:0xf
v_and_b32_dpp v27, v21, v15 row_newbcast:6 row_mask:0xf bank_mask:0xf
s_nop 1
v_mfma_f32_16x16x32_bf16 v[28:31], v[24:27], v[120:123], v[28:31]
v_add3_u32 v49, v8, v9, s68
v_and_b32 v8, 7, v1
v_lshrrev_b32 v7, 5, v1
v_lshl_add_u32 v7, v7, 4, v8
v_mul_u32_u24 v7, 144, v7
v_bfe_u32 v9, v1, 3, 2
v_add_u32 v10, v39, v9
v_lshl_add_u32 v50, v10, 2, v7
s_and_b32 s68, s3, 4
s_lshl_b32 s68, s68, 2
s_and_b32 s69, s3, 1
s_lshl3_add_u32 s68, s69, s68
s_and_b32 s69, s3, 2
s_lshl1_add_u32 s68, s69, s68
v_add_lshl_u32 v58, v9, s68, 1
v_lshlrev_b32 v59, 4, v2
v_lshlrev_b32 v62, 3, v8
s_mul_i32 s64, s67, 36864
v_add_u32 v7, 0, v0
v_mul_u32_u24 v9, 3543, v7
v_lshrrev_b32 v9, 18, v9
v_mul_u32_u24 v10, 74, v9
v_sub_u32 v10, v7, v10
v_cmp_gt_u32 vcc, 72, v10
v_lshlrev_b32 v9, 1, v9
v_sub_u32 v9, v7, v9
v_lshlrev_b32 v9, 4, v9
v_cndmask_b32 v124, v22, v9, vcc
v_add_u32 v7, 512, v0
v_mul_u32_u24 v9, 3543, v7
s_waitcnt vmcnt(5)
buffer_load_dwordx4 v[160:163], v4, s[32:35], s65 offen nt
s_addk_i32 s65, 8192
v_and_b32_dpp v24, v21, v12 row_newbcast:7 row_mask:0xf bank_mask:0xf
v_and_b32_dpp v25, v21, v13 row_newbcast:7 row_mask:0xf bank_mask:0xf
v_and_b32_dpp v26, v21, v14 row_newbcast:7 row_mask:0xf bank_mask:0xf
v_and_b32_dpp v27, v21, v15 row_newbcast:7 row_mask:0xf bank_mask:0xf
s_nop 1
v_mfma_f32_16x16x32_bf16 v[28:31], v[24:27], v[136:139], v[28:31]
v_lshrrev_b32 v9, 18, v9
v_mul_u32_u24 v10, 74, v9
v_sub_u32 v10, v7, v10
v_cmp_gt_u32 vcc, 72, v10
v_lshlrev_b32 v9, 1, v9
v_sub_u32 v9, v7, v9
v_lshlrev_b32 v9, 4, v9
v_cndmask_b32 v125, v22, v9, vcc
v_add_u32 v7, 1024, v0
v_mul_u32_u24 v9, 3543, v7
v_lshrrev_b32 v9, 18, v9
v_mul_u32_u24 v10, 74, v9
v_sub_u32 v10, v7, v10
v_cmp_gt_u32 vcc, 72, v10
v_lshlrev_b32 v9, 1, v9
v_sub_u32 v9, v7, v9
v_lshlrev_b32 v9, 4, v9
v_cndmask_b32 v126, v22, v9, vcc
v_add_u32 v7, 1536, v0
v_mul_u32_u24 v9, 3543, v7
v_lshrrev_b32 v9, 18, v9
v_mul_u32_u24 v10, 74, v9
v_sub_u32 v10, v7, v10
v_cmp_gt_u32 vcc, 72, v10
v_lshlrev_b32 v9, 1, v9
v_sub_u32 v9, v7, v9
v_lshlrev_b32 v9, 4, v9
v_cndmask_b32 v127, v22, v9, vcc
v_add_u32 v7, 2048, v0
v_mul_u32_u24 v9, 3543, v7
s_waitcnt vmcnt(3)
buffer_load_dwordx4 v[168:171], v4, s[32:35], s65 offen nt
s_addk_i32 s65, 8192
v_and_b32_dpp v24, v21, v12 row_newbcast:8 row_mask:0xf bank_mask:0xf
v_and_b32_dpp v25, v21, v13 row_newbcast:8 row_mask:0xf bank_mask:0xf
v_and_b32_dpp v26, v21, v14 row_newbcast:8 row_mask:0xf bank_mask:0xf
v_and_b32_dpp v27, v21, v15 row_newbcast:8 row_mask:0xf bank_mask:0xf
s_nop 1
v_mfma_f32_16x16x32_bf16 v[28:31], v[24:27], v[144:147], v[28:31]
v_lshrrev_b32 v9, 18, v9
v_mul_u32_u24 v10, 74, v9
v_sub_u32 v10, v7, v10
v_cmp_gt_u32 vcc, 72, v10
v_lshlrev_b32 v9, 1, v9
v_sub_u32 v9, v7, v9
v_lshlrev_b32 v9, 4, v9
v_cndmask_b32 v132, v22, v9, vcc
v_cmp_gt_u32 vcc, 320, v0
v_lshrrev_b32 v7, 2, v3
v_and_b32 v9, 1, v2
v_cndmask_b32 v132, v22, v132, vcc
v_lshl_add_u32 v7, v9, 2, v7
v_lshrrev_b32 v9, 1, v2
v_lshl_add_u32 v7, v9, 4, v7
v_mul_u32_u24 v7, 1184, v7
v_and_b32 v9, 3, v1
v_lshl_add_u32 v7, v9, 3, v7
s_mul_i32 s69, s3, 144
v_add_u32 v35, s69, v7
s_waitcnt vmcnt(3)
buffer_load_dwordx4 v[172:175], v4, s[32:35], s65 offen nt
s_addk_i32 s65, 8192
v_and_b32_dpp v24, v21, v12 row_newbcast:9 row_mask:0xf bank_mask:0xf
v_and_b32_dpp v25, v21, v13 row_newbcast:9 row_mask:0xf bank_mask:0xf
v_and_b32_dpp v26, v21, v14 row_newbcast:9 row_mask:0xf bank_mask:0xf
v_and_b32_dpp v27, v21, v15 row_newbcast:9 row_mask:0xf bank_mask:0xf
s_nop 1
v_mfma_f32_16x16x32_bf16 v[28:31], v[24:27], v[148:151], v[28:31]
s_waitcnt vmcnt(3)
buffer_load_dwordx4 v[180:183], v4, s[32:35], s65 offen nt
s_addk_i32 s65, 8192
v_and_b32_dpp v24, v21, v12 row_newbcast:10 row_mask:0xf bank_mask:0xf
v_and_b32_dpp v25, v21, v13 row_newbcast:10 row_mask:0xf bank_mask:0xf
v_and_b32_dpp v26, v21, v14 row_newbcast:10 row_mask:0xf bank_mask:0xf
v_and_b32_dpp v27, v21, v15 row_newbcast:10 row_mask:0xf bank_mask:0xf
s_nop 1
v_mfma_f32_16x16x32_bf16 v[28:31], v[24:27], v[156:159], v[28:31]
s_waitcnt vmcnt(3)
buffer_load_dwordx4 v[184:187], v4, s[32:35], s65 offen nt
v_and_b32_dpp v24, v21, v12 row_newbcast:11 row_mask:0xf bank_mask:0xf
v_and_b32_dpp v25, v21, v13 row_newbcast:11 row_mask:0xf bank_mask:0xf
v_and_b32_dpp v26, v21, v14 row_newbcast:11 row_mask:0xf bank_mask:0xf
v_and_b32_dpp v27, v21, v15 row_newbcast:11 row_mask:0xf bank_mask:0xf
s_nop 1
v_mfma_f32_16x16x32_bf16 v[28:31], v[24:27], v[160:163], v[28:31]
s_waitcnt vmcnt(3)
buffer_load_dword v250, v54, s[12:15], s101 offen
v_and_b32_dpp v24, v21, v12 row_newbcast:12 row_mask:0xf bank_mask:0xf
v_and_b32_dpp v25, v21, v13 row_newbcast:12 row_mask:0xf bank_mask:0xf
v_and_b32_dpp v26, v21, v14 row_newbcast:12 row_mask:0xf bank_mask:0xf
v_and_b32_dpp v27, v21, v15 row_newbcast:12 row_mask:0xf bank_mask:0xf
s_nop 1
v_mfma_f32_16x16x32_bf16 v[28:31], v[24:27], v[168:171], v[28:31]
s_waitcnt vmcnt(3)
buffer_load_dword v248, v55, s[48:51], s66 offen
v_and_b32_dpp v24, v21, v12 row_newbcast:13 row_mask:0xf bank_mask:0xf
v_and_b32_dpp v25, v21, v13 row_newbcast:13 row_mask:0xf bank_mask:0xf
v_and_b32_dpp v26, v21, v14 row_newbcast:13 row_mask:0xf bank_mask:0xf
v_and_b32_dpp v27, v21, v15 row_newbcast:13 row_mask:0xf bank_mask:0xf
s_nop 1
v_mfma_f32_16x16x32_bf16 v[28:31], v[24:27], v[172:175], v[28:31]
s_waitcnt vmcnt(3)
buffer_load_dword v249, v55, s[8:11], s66 offen
v_and_b32_dpp v24, v21, v12 row_newbcast:14 row_mask:0xf bank_mask:0xf
v_and_b32_dpp v25, v21, v13 row_newbcast:14 row_mask:0xf bank_mask:0xf
v_and_b32_dpp v26, v21, v14 row_newbcast:14 row_mask:0xf bank_mask:0xf
v_and_b32_dpp v27, v21, v15 row_newbcast:14 row_mask:0xf bank_mask:0xf
s_nop 1
v_mfma_f32_16x16x32_bf16 v[28:31], v[24:27], v[180:183], v[28:31]
v_and_b32_dpp v24, v21, v12 row_newbcast:15 row_mask:0xf bank_mask:0xf
v_and_b32_dpp v25, v21, v13 row_newbcast:15 row_mask:0xf bank_mask:0xf
v_and_b32_dpp v26, v21, v14 row_newbcast:15 row_mask:0xf bank_mask:0xf
v_and_b32_dpp v27, v21, v15 row_newbcast:15 row_mask:0xf bank_mask:0xf
s_waitcnt vmcnt(3)
s_nop 0
v_mfma_f32_16x16x32_bf16 v[28:31], v[24:27], v[184:187], v[28:31]
s_mov_b32 exec_hi, 0
s_nop 6
ds_write_b128 v38, v[28:31] offset:4608
s_mov_b32 exec_hi, -1
s_waitcnt lgkmcnt(0)
s_barrier
ds_read_b128 v[240:243], v32 offset:4608
s_cmp_eq_u32 s77, 1
s_waitcnt lgkmcnt(0)
v_add_f32_dpp v240, v240, v240 row_ror:8 row_mask:0xf bank_mask:0x3
v_add_f32_dpp v241, v241, v241 row_ror:8 row_mask:0xf bank_mask:0x3
v_add_f32_dpp v240, v242, v242 row_ror:8 row_mask:0xf bank_mask:0xc
v_add_f32_dpp v241, v243, v243 row_ror:8 row_mask:0xf bank_mask:0xc
s_nop 1
v_permlane16_swap_b32 v240, v241
v_add_f32 v240, v240, v241
v_mov_b32 v241, v240
s_nop 1
v_permlane32_swap_b32 v240, v241
v_add_f32 v240, v240, v241
v_min_u32 v240, -2, v240
s_cbranch_scc1 L_pl3
buffer_store_dword v240, v36, s[44:47], s78 offen sc1
s_branch L_pe3
L_pl3:
buffer_store_dword v240, v36, s[44:47], s78 offen
L_pe3:
global_load_dwordx4 v[208:211], v[56:57], off
v_add_co_u32 v56, vcc, 9216, v56
s_nop 1
v_addc_co_u32 v57, vcc, 0, v57, vcc
global_load_dwordx4 v[216:219], v[56:57], off
v_add_co_u32 v56, vcc, 9216, v56
s_nop 1
v_addc_co_u32 v57, vcc, 0, v57, vcc
global_load_dwordx4 v[220:223], v[56:57], off
v_add_co_u32 v56, vcc, 9216, v56
s_nop 1
v_addc_co_u32 v57, vcc, 0, v57, vcc
global_load_dwordx4 v[228:231], v[56:57], off
v_add_co_u32 v56, vcc, 9216, v56
s_nop 1
v_addc_co_u32 v57, vcc, 0, v57, vcc
global_load_dwordx4 v[232:235], v[56:57], off
v_add_co_u32 v56, vcc, 9216, v56
s_nop 1
v_addc_co_u32 v57, vcc, 0, v57, vcc
global_load_dwordx4 v[80:83], v[56:57], off
v_add_co_u32 v56, vcc, 9216, v56
s_nop 1
v_addc_co_u32 v57, vcc, 0, v57, vcc
global_load_dwordx4 v[92:95], v[56:57], off
v_add_co_u32 v56, vcc, 9216, v56
s_nop 1
v_addc_co_u32 v57, vcc, 0, v57, vcc
global_load_dwordx4 v[152:155], v[56:57], off
v_add_co_u32 v56, vcc, 9216, v56
s_nop 1
v_addc_co_u32 v57, vcc, 0, v57, vcc
global_load_dwordx4 v[164:167], v[56:57], off
s_barrier
buffer_load_dword v205, v60, s[44:47], 0 offen sc1
s_mov_b32 m0, s70
s_addk_i32 s70, 0x2000
buffer_load_dwordx4 v124, s[52:55], s64 offen nt lds
s_mov_b32 m0, s70
s_addk_i32 s70, 0x2000
buffer_load_dwordx4 v125, s[52:55], s64 offen nt lds
s_mov_b32 m0, s70
s_addk_i32 s70, 0x2000
buffer_load_dwordx4 v126, s[52:55], s64 offen nt lds
s_mov_b32 m0, s70
s_addk_i32 s70, 0x2000
buffer_load_dwordx4 v127, s[52:55], s64 offen nt lds
s_mov_b32 m0, s70
s_addk_i32 s70, 0x2000
buffer_load_dwordx4 v132, s[52:55], s64 offen nt lds
v_and_b32 v240, 0x3f803f80, v12
v_and_b32 v241, 0x3f803f80, v13
v_and_b32 v242, 0x3f803f80, v14
v_and_b32 v243, 0x3f803f80, v15
v_lshlrev_b32 v51, 16, v51
v_lshlrev_b32 v52, 16, v52
s_mov_b32 s69, 0xbfb8aa3b
v_mov_b32 v11, 0
s_waitcnt vmcnt(14)
v_mfma_f32_16x16x32_bf16 v[244:247], v[240:243], v[208:211], 0
s_waitcnt vmcnt(13)
v_mfma_f32_16x16x32_bf16 v[244:247], v[240:243], v[216:219], v[244:247]
s_waitcnt vmcnt(12)
v_mfma_f32_16x16x32_bf16 v[244:247], v[240:243], v[220:223], v[244:247]
s_waitcnt vmcnt(11)
v_mfma_f32_16x16x32_bf16 v[244:247], v[240:243], v[228:231], v[244:247]
s_waitcnt vmcnt(10)
v_mfma_f32_16x16x32_bf16 v[244:247], v[240:243], v[232:235], v[244:247]
s_waitcnt vmcnt(9)
v_mfma_f32_16x16x32_bf16 v[244:247], v[240:243], v[80:83], v[244:247]
s_waitcnt vmcnt(8)
v_mfma_f32_16x16x32_bf16 v[244:247], v[240:243], v[92:95], v[244:247]
s_waitcnt vmcnt(7)
v_mfma_f32_16x16x32_bf16 v[244:247], v[240:243], v[152:155], v[244:247]
s_waitcnt vmcnt(6)
v_mfma_f32_16x16x32_bf16 v[244:247], v[240:243], v[164:167], v[244:247]
s_waitcnt vmcnt(5)
v_cmp_eq_u32 vcc, -1, v205
s_nop 0
s_bcnt1_i32_b64 s19, vcc
v_mov_b32 v6, s19
ds_write_b32 v39, v6 offset:8896
s_mov_b64 exec, s[72:73]
s_nop 0
ds_write_b128 v49, v[244:247] offset:16896
s_mov_b64 exec, -1
s_waitcnt lgkmcnt(0)
s_barrier
ds_read_b32 v6, v11 offset:8896
ds_read_b32 v46, v50 offset:16896
ds_read_b32 v7, v50 offset:18048
s_waitcnt lgkmcnt(2)
v_readfirstlane_b32 s19, v6
s_nop 0
s_cmp_le_u32 s19, 16
s_cbranch_scc1 L_go2
s_cmp_lg_u32 s3, 0
s_cbranch_scc1 L_g2
L_gate2:
buffer_load_dword v205, v60, s[44:47], 0 offen sc1
s_waitcnt vmcnt(0)
v_cmp_eq_u32 vcc, -1, v205
s_nop 0
s_bcnt1_i32_b64 s68, vcc
s_cmp_le_u32 s68, 16
s_cbranch_scc1 L_gateok2
s_sub_u32 s71, s71, 1
s_cbranch_scc0 L_gate2
s_mov_b32 s71, 0
L_gateok2:
L_g2:
s_barrier
L_go2:
buffer_load_dword v72, v53, s[44:47], 0 offen offset:256 sc1
buffer_load_dword v64, v42, s[44:47], 0 offen offset:0 sc1
buffer_load_dword v65, v42, s[44:47], 0 offen offset:2304 sc1
buffer_load_dword v66, v42, s[44:47], s16 offen offset:0 sc1
buffer_load_dword v67, v42, s[44:47], s17 offen offset:0 sc1
buffer_load_dword v68, v42, s[44:47], s17 offen offset:2304 sc1
buffer_load_dword v69, v42, s[44:47], s18 offen offset:0 sc1
buffer_load_dword v70, v42, s[44:47], s20 offen offset:0 sc1
buffer_load_dword v71, v42, s[44:47], s20 offen offset:2304 sc1
s_waitcnt lgkmcnt(0)
v_add_f32 v46, v46, v7
s_nop 1
v_add_f32_dpp v46, v46, v46 quad_perm:[1,0,3,2] row_mask:0xf bank_mask:0xf
s_nop 1
v_add_f32_dpp v46, v46, v46 quad_perm:[2,3,0,1] row_mask:0xf bank_mask:0xf
s_nop 1
v_add_f32_dpp v46, v46, v46 row_half_mirror row_mask:0xf bank_mask:0xf
L_pollF2:
s_waitcnt vmcnt(0)
v_max3_u32 v6, v72, v64, v65
v_max3_u32 v6, v6, v66, v67
v_max3_u32 v6, v6, v68, v69
v_max3_u32 v6, v6, v70, v71
v_cmp_eq_u32 vcc, -1, v6
s_cbranch_vccz L_pollokF2
v_cmp_eq_u32 vcc, -1, v72
s_cbranch_vccz L_skF2_0
buffer_load_dword v72, v53, s[44:47], 0 offen offset:256 sc1
L_skF2_0:
v_cmp_eq_u32 vcc, -1, v64
s_cbranch_vccz L_skF2_1
buffer_load_dword v64, v42, s[44:47], 0 offen offset:0 sc1
L_skF2_1:
v_cmp_eq_u32 vcc, -1, v65
s_cbranch_vccz L_skF2_2
buffer_load_dword v65, v42, s[44:47], 0 offen offset:2304 sc1
L_skF2_2:
v_cmp_eq_u32 vcc, -1, v66
s_cbranch_vccz L_skF2_3
buffer_load_dword v66, v42, s[44:47], s16 offen offset:0 sc1
L_skF2_3:
v_cmp_eq_u32 vcc, -1, v67
s_cbranch_vccz L_skF2_4
buffer_load_dword v67, v42, s[44:47], s17 offen offset:0 sc1
L_skF2_4:
v_cmp_eq_u32 vcc, -1, v68
s_cbranch_vccz L_skF2_5
buffer_load_dword v68, v42, s[44:47], s17 offen offset:2304 sc1
L_skF2_5:
v_cmp_eq_u32 vcc, -1, v69
s_cbranch_vccz L_skF2_6
buffer_load_dword v69, v42, s[44:47], s18 offen offset:0 sc1
L_skF2_6:
v_cmp_eq_u32 vcc, -1, v70
s_cbranch_vccz L_skF2_7
buffer_load_dword v70, v42, s[44:47], s20 offen offset:0 sc1
L_skF2_7:
v_cmp_eq_u32 vcc, -1, v71
s_cbranch_vccz L_skF2_8
buffer_load_dword v71, v42, s[44:47], s20 offen offset:2304 sc1
L_skF2_8:
s_sub_u32 s71, s71, 1
s_cbranch_scc0 L_pollF2
s_mov_b32 s71, 0
s_waitcnt vmcnt(0)
L_pollokF2:
v_add_f32_dpp v17, v72, v72 row_ror:8 row_mask:0xf bank_mask:0xf
v_add_f32 v16, v64, v65
v_add_f32 v18, v66, v67
v_mov_b32 v6, v17
v_add_f32 v19, v68, v69
v_add_f32 v7, v70, v71
v_permlane16_swap_b32 v17, v6
v_add_f32 v16, v16, v18
v_add_f32 v17, v17, v6
v_add_f32 v19, v19, v7
v_mov_b32 v6, v17
v_add_f32 v16, v16, v19
v_cvt_pk_bf16_f32 v16, v16, v16
v_permlane32_swap_b32 v17, v6
v_and_b32 v16, 0xffff0000, v16
v_add_f32 v17, v17, v6
v_add_f32 v16, v16, v51
v_cvt_pk_bf16_f32 v17, v17, v17
v_cvt_pk_bf16_f32 v16, v16, v16
v_and_b32 v17, 0xffff0000, v17
ds_write_b32 v44, v16
v_add_f32 v17, v17, v52
v_cvt_pk_bf16_f32 v17, v17, v17
ds_write_b32 v45, v17
ds_read_b128 v[192:195], v48 offset:9216
ds_read_b128 v[196:199], v48 offset:9232
ds_read_b32 v204, v48 offset:9248
v_and_b32 v16, 0xffff0000, v16
v_and_b32 v17, 0xffff0000, v17
v_cndmask_b32 v17, 0, v17, s[74:75]
v_add_f32 v8, v16, v17
v_mul_f32 v9, v16, v16
v_fmac_f32 v9, v17, v17
v_add_f32_dpp v8, v8, v8 row_ror:8 row_mask:0xf bank_mask:0xf
s_nop 0
v_add_f32_dpp v9, v9, v9 row_ror:8 row_mask:0xf bank_mask:0xf
s_waitcnt lgkmcnt(0)
v_and_b32 v24, v192, v12
v_and_b32 v25, v192, v13
v_and_b32 v26, v192, v14
v_and_b32 v27, v192, v15
v_add_f32_dpp v8, v8, v8 row_ror:4 row_mask:0xf bank_mask:0xf
v_add_f32_dpp v9, v9, v9 row_ror:4 row_mask:0xf bank_mask:0xf
v_and_b32 v240, v193, v12
v_and_b32 v241, v193, v13
v_and_b32 v242, v193, v14
v_and_b32 v243, v193, v15
v_mfma_f32_16x16x32_bf16 v[28:31], v[24:27], v[208:211], 0
v_add_f32_dpp v8, v8, v8 row_ror:2 row_mask:0xf bank_mask:0xf
v_add_f32_dpp v9, v9, v9 row_ror:2 row_mask:0xf bank_mask:0xf
v_and_b32 v24, v194, v12
v_and_b32 v25, v194, v13
v_and_b32 v26, v194, v14
v_and_b32 v27, v194, v15
v_mfma_f32_16x16x32_bf16 v[28:31], v[240:243], v[216:219], v[28:31]
v_add_f32_dpp v8, v8, v8 row_ror:1 row_mask:0xf bank_mask:0xf
v_add_f32_dpp v9, v9, v9 row_ror:1 row_mask:0xf bank_mask:0xf
v_and_b32 v240, v195, v12
v_and_b32 v241, v195, v13
v_and_b32 v242, v195, v14
v_and_b32 v243, v195, v15
v_mfma_f32_16x16x32_bf16 v[28:31], v[24:27], v[220:223], v[28:31]
v_add_f32_dpp v8, v8, v8 row_bcast:15 row_mask:0xa bank_mask:0xf
v_add_f32_dpp v9, v9, v9 row_bcast:15 row_mask:0xa bank_mask:0xf
v_and_b32 v24, v196, v12
v_and_b32 v25, v196, v13
v_and_b32 v26, v196, v14
v_and_b32 v27, v196, v15
v_mfma_f32_16x16x32_bf16 v[28:31], v[240:243], v[228:231], v[28:31]
v_add_f32_dpp v8, v8, v8 row_bcast:31 row_mask:0xc bank_mask:0xf
v_add_f32_dpp v9, v9, v9 row_bcast:31 row_mask:0xc bank_mask:0xf
v_and_b32 v240, v197, v12
v_and_b32 v241, v197, v13
v_and_b32 v242, v197, v14
v_and_b32 v243, v197, v15
v_mfma_f32_16x16x32_bf16 v[28:31], v[24:27], v[232:235], v[28:31]
ds_write_b64 v47, v[8:9]
v_and_b32 v24, v198, v12
v_and_b32 v25, v198, v13
v_and_b32 v26, v198, v14
v_and_b32 v27, v198, v15
v_mfma_f32_16x16x32_bf16 v[28:31], v[240:243], v[80:83], v[28:31]
v_and_b32 v240, v199, v12
v_and_b32 v241, v199, v13
v_and_b32 v242, v199, v14
v_and_b32 v243, v199, v15
v_mfma_f32_16x16x32_bf16 v[28:31], v[24:27], v[92:95], v[28:31]
s_waitcnt lgkmcnt(0)
s_barrier
ds_read_b64 v[8:9], v62 offset:8704
v_and_b32 v24, v204, v12
v_and_b32 v25, v204, v13
v_and_b32 v26, v204, v14
v_and_b32 v27, v204, v15
v_mfma_f32_16x16x32_bf16 v[28:31], v[240:243], v[152:155], v[28:31]
s_nop 0
v_mfma_f32_16x16x32_bf16 v[28:31], v[24:27], v[164:167], v[28:31]
s_waitcnt lgkmcnt(0)
v_add_f32_dpp v8, v8, v8 quad_perm:[1,0,3,2] row_mask:0xf bank_mask:0xf
v_add_f32_dpp v9, v9, v9 quad_perm:[1,0,3,2] row_mask:0xf bank_mask:0xf
s_nop 0
v_add_f32_dpp v8, v8, v8 quad_perm:[2,3,0,1] row_mask:0xf bank_mask:0xf
v_add_f32_dpp v9, v9, v9 quad_perm:[2,3,0,1] row_mask:0xf bank_mask:0xf
s_nop 0
v_add_f32_dpp v8, v8, v8 row_half_mirror row_mask:0xf bank_mask:0xf
v_add_f32_dpp v9, v9, v9 row_half_mirror row_mask:0xf bank_mask:0xf
s_mov_b64 exec, s[72:73]
ds_write_b128 v49, v[28:31] offset:12288
s_mov_b64 exec, -1
v_mul_f32 v8, 0x3ae38e39, v8
v_mul_f32 v9, 0x3ae38e39, v9
v_fma_f32 v9, -v8, v8, v9
v_max_f32 v9, 0, v9
v_cvt_pk_bf16_f32 v9, v9, v9
v_cvt_pk_bf16_f32 v8, v8, v8
v_and_b32 v9, 0xffff0000, v9
v_add_f32 v9, 0x3727c5ac, v9
v_cvt_pk_bf16_f32 v9, v9, v9
v_and_b32 v9, 0xffff0000, v9
v_sqrt_f32 v9, v9
v_and_b32 v8, 0xffff0000, v8
v_cvt_pk_bf16_f32 v9, v9, v9
v_and_b32 v9, 0xffff0000, v9
v_rcp_f32 v9, v9
s_waitcnt lgkmcnt(0)
s_barrier
ds_read_b32 v10, v50 offset:12288
ds_read_b32 v7, v50 offset:13440
ds_read_b64_tr_b16 v[176:177], v35 offset:21504
ds_read_b64_tr_b16 v[178:179], v35 offset:30976
ds_read_b64_tr_b16 v[188:189], v35 offset:21536
ds_read_b64_tr_b16 v[190:191], v35 offset:31008
ds_read_b64_tr_b16 v[200:201], v35 offset:21568
ds_read_b64_tr_b16 v[202:203], v35 offset:31040
ds_read_b64_tr_b16 v[212:213], v35 offset:21600
ds_read_b64_tr_b16 v[214:215], v35 offset:31072
ds_read_b64_tr_b16 v[224:225], v35 offset:21632
ds_read_b64_tr_b16 v[226:227], v35 offset:31104
v_mul_f32 v46, v46, v8
s_waitcnt lgkmcnt(10)
v_add_f32 v10, v10, v7
s_nop 1
v_add_f32_dpp v10, v10, v10 quad_perm:[1,0,3,2] row_mask:0xf bank_mask:0xf
s_nop 1
v_add_f32_dpp v10, v10, v10 quad_perm:[2,3,0,1] row_mask:0xf bank_mask:0xf
s_nop 1
v_add_f32_dpp v10, v10, v10 row_half_mirror row_mask:0xf bank_mask:0xf
v_sub_f32 v10, v10, v46
v_mul_f32 v10, v10, v9
v_cvt_pk_bf16_f32 v10, v10, v10
v_and_b32 v10, 0xffff0000, v10
v_mov_b32 v7, v10
v_mul_f32 v6, s69, v10
v_exp_f32 v6, v6
v_permlane32_swap_b32 v10, v7
v_add_f32 v6, 1.0, v6
v_rcp_f32 v6, v6
s_mov_b32 exec_hi, 0
v_mul_f32 v6, v10, v6
v_cvt_pk_bf16_f32 v6, v6, v6
v_and_b32 v6, 0xffff0000, v6
v_mul_f32 v6, v6, v7
v_cvt_pk_bf16_f32 v6, v6, v6
ds_write_b16 v58, v6 offset:8960
s_mov_b32 exec_hi, -1
s_waitcnt lgkmcnt(0)
s_barrier
ds_read_b128 v[24:27], v59 offset:8960
s_waitcnt lgkmcnt(0)
v_mfma_f32_16x16x32_bf16 v[140:143], v[24:27], v[224:227], 0
v_mfma_f32_16x16x32_bf16 v[236:239], v[24:27], v[176:179], 0
v_mfma_f32_16x16x32_bf16 v[104:107], v[24:27], v[188:191], 0
v_mfma_f32_16x16x32_bf16 v[116:119], v[24:27], v[200:203], 0
v_mfma_f32_16x16x32_bf16 v[128:131], v[24:27], v[212:215], 0
s_nop 3
v_min_u32 v140, -2, v140
buffer_store_dword v140, v61, s[44:47], 0 offen sc1
v_mov_b32_dpp v236, v104 quad_perm:[0,1,2,3] row_mask:0x2 bank_mask:0xf
v_mov_b32_dpp v236, v116 quad_perm:[0,1,2,3] row_mask:0x4 bank_mask:0xf
v_mov_b32_dpp v236, v128 quad_perm:[0,1,2,3] row_mask:0x8 bank_mask:0xf
v_min_u32 v236, -2, v236
buffer_store_dword v236, v43, s[44:47], 0 offen sc1
s_endpgm
L_done:
s_endpgm
L_end:
.section .rodata,"a"
.p2align 6
.amdhsa_kernel sequential_preLN__mha_block_cached__glu_gated_swiglu__decode_kernel
  .amdhsa_next_free_vgpr 256
  .amdhsa_next_free_sgpr 102
  .amdhsa_accum_offset 256
  .amdhsa_group_segment_fixed_size 0
  .amdhsa_kernarg_size 96
  .amdhsa_user_sgpr_count 2
  .amdhsa_user_sgpr_kernarg_segment_ptr 1
  .amdhsa_system_sgpr_workgroup_id_x 1
.end_amdhsa_kernel
```
